```python
import torch

def _softmax(x, axis=-1):
    return torch.softmax(x, dim=axis)
def _gelu(x):
    return torch.nn.functional.gelu(x, approximate="tanh")
def _silu(x):
    return torch.nn.functional.silu(x)
def _sigmoid(x):
    return torch.sigmoid(x)
def _layernorm(x, axis=-1, eps=1e-5):
    m = x.mean(dim=axis, keepdim=True)
    v = x.var(dim=axis, keepdim=True, unbiased=False)
    return (x - m) / torch.sqrt(v + eps)
def _scatter_add(tgt, idx, src, axis=0):
    return tgt.clone().index_add_(axis, idx, src)
def _segment_sum(src, seg, n):
    out = torch.zeros((n,) + src.shape[1:], dtype=src.dtype)
    return out.index_add_(0, seg, src)
def _pad(x, pw):
    flat = tuple(v for pair in reversed(pw) for v in pair)
    return torch.nn.functional.pad(x, flat)

kernel_name = 'gated_mix__linear_kernel_hedgehog__ssm_conv_s4__prompt'

def setup_inputs():

    _w = (lambda a: (lambda t: t.to(torch.bfloat16) if t.is_floating_point() else t)(torch.as_tensor(a)))
    def _A_setup():
        B, S, D, H = 1, 2048, 512, 32
        Dh = D // H
        return {
            "x": _w((lambda *s: torch.randn(*s, dtype=torch.bfloat16) * 0.05)(B, S, D)),
            "wqkv": _w((lambda *s: torch.randn(*s, dtype=torch.bfloat16) * 0.8)(D, 3 * D)),
            "w_phi": _w((lambda *s: torch.randn(*s, dtype=torch.bfloat16) * 0.8)(H, Dh, Dh) * (Dh ** -0.5)),
            "wo": _w((lambda *s: torch.randn(*s, dtype=torch.bfloat16) * 0.05)(D, D)),
        }
    _A_in = _A_setup()

    def _B_setup():
        B, L, D, N = 1, 2048, 512, 128
        A_re = -(lambda _x: torch.exp(torch.as_tensor(_x)))((lambda *s: torch.randn(*s, dtype=torch.bfloat16) * 3.2)(D, N))
        A_im = torch.pi * (lambda *s: torch.randn(*s, dtype=torch.bfloat16) * 0.05)(D, N)
        B_re = (lambda *s: torch.randn(*s, dtype=torch.bfloat16) * 0.2)(D, N)
        B_im = (lambda *s: torch.randn(*s, dtype=torch.bfloat16) * 0.2)(D, N)
        C_re = (lambda *s: torch.randn(*s, dtype=torch.bfloat16) * 0.2)(D, N)
        C_im = (lambda *s: torch.randn(*s, dtype=torch.bfloat16) * 0.2)(D, N)
        log_dt = (lambda *s: torch.randn(*s, dtype=torch.bfloat16) * 0.05)(D) * 0.5 - 4.0
        Dskip = (lambda *s: torch.randn(*s, dtype=torch.bfloat16) * 0.05)(D)
        return {
            "u": _w((lambda *s: torch.randn(*s, dtype=torch.bfloat16) * 0.05)(B, L, D)),
            "A_re": _w(A_re),
            "A_im": _w(A_im),
            "B_re": _w(B_re),
            "B_im": _w(B_im),
            "C_re": _w(C_re),
            "C_im": _w(C_im),
            "log_dt": _w(log_dt),
            "Dskip": _w(Dskip),
        }
    _B_in = _B_setup()

    return {
        "A_x": _A_in["x"],
        "A_wqkv": _A_in["wqkv"],
        "A_w_phi": _A_in["w_phi"],
        "A_wo": _A_in["wo"],
        "B_u": _B_in["u"],
        "B_A_re": _B_in["A_re"],
        "B_A_im": _B_in["A_im"],
        "B_B_re": _B_in["B_re"],
        "B_B_im": _B_in["B_im"],
        "B_C_re": _B_in["C_re"],
        "B_C_im": _B_in["C_im"],
        "B_log_dt": _B_in["log_dt"],
        "B_Dskip": _B_in["Dskip"],
        "gate_w": _w((lambda *s: torch.randn(*s, dtype=torch.bfloat16) * 0.05)(512) * 16.0),
    }

def reference(A_x, A_wqkv, A_w_phi, A_wo, B_u, B_A_re, B_A_im, B_B_re, B_B_im, B_C_re, B_C_im, B_log_dt, B_Dskip, gate_w):
    def _A_ref(x, wqkv, w_phi, wo):
        B, S, D = x.shape
        H = 32; Dh = D // H
        qkv = (lambda x, *d: x.permute(*d))((x @ wqkv).reshape(B, S, 3, H, Dh), 2, 0, 3, 1, 4)
        q, k, v = qkv[0], qkv[1], qkv[2]
        pq = torch.einsum("bhsd,hdf->bhsf", q, w_phi)
        pk = torch.einsum("bhsd,hdf->bhsf", k, w_phi)
        phi_q = torch.concatenate([_softmax(pq, axis=-1), _softmax(-pq, axis=-1)], axis=-1)
        phi_k = torch.concatenate([_softmax(pk, axis=-1), _softmax(-pk, axis=-1)], axis=-1)
        kv = torch.einsum("bhsf,bhsd->bhfd", phi_k, v)
        z  = torch.einsum("bhsf->bhf", phi_k)
        num = torch.einsum("bhqf,bhfd->bhqd", phi_q, kv)
        den = torch.einsum("bhqf,bhf->bhq", phi_q, z)[..., None] + 1e-6
        o = num / den
        return (lambda x, *d: x.permute(*d))(o, 0, 2, 1, 3).reshape(B, S, D) @ wo

    def _B_ref(u, A_re, A_im, B_re, B_im, C_re, C_im, log_dt, Dskip):
        Bsz, L, D = u.shape
        dt = torch.exp(log_dt)[:, None]
        A = A_re + 1j * A_im
        Bc = B_re + 1j * B_im
        Cc = C_re + 1j * C_im
        logdA = dt * A
        dB = dt * Bc
        l = (lambda x, dt: x.to(dt))(torch.arange(L), A_re.dtype)
        P = torch.exp(logdA[:, :, None] * l[None, None, :])
        K = torch.einsum("dn,dnl,dn->dl", Cc, P, dB).real
        L2 = 2 * L
        Kp = _pad(K, ((0, 0), (0, L)))
        up = (lambda x, *d: x.permute(*d))(u, 0, 2, 1)
        up = _pad(up, ((0, 0), (0, 0), (0, L)))
        Kf = (lambda x, axes=(-2,-1): torch.fft.rfft2(x.float(), dim=axes))(Kp[:, None, :], axes=(-2, -1))
        Uf = (lambda x, axes=(-2,-1): torch.fft.rfft2(x.float(), dim=axes))(up[:, :, None, :], axes=(-2, -1))
        Yf = Uf * Kf[None, :, :, :]
        y = (lambda x, s, axes=(-2,-1): torch.fft.irfft2(x, s=s, dim=axes).to(torch.bfloat16))(Yf, (1, L2), axes=(-2, -1))[:, :, 0, :L]
        y = (lambda x, *d: x.permute(*d))(y, 0, 2, 1) + u * Dskip[None, None, :]
        return y

    x = A_x
    g = _sigmoid((x * gate_w).sum(-1, keepdims=True))
    a = _A_ref(x, A_wqkv, A_w_phi, A_wo)
    b = _B_ref(x, B_A_re, B_A_im, B_B_re, B_B_im, B_C_re, B_C_im, B_log_dt, B_Dskip)
    return g * a + (1 - g) * b
```

```asm
; @launch grid=(512,1,1) block=(256,1,1) lds=81920
.amdgcn_target "amdgcn-amd-amdhsa--gfx950"
.text
.globl gated_mix__linear_kernel_hedgehog__ssm_conv_s4__prompt_kernel
.p2align 8
.type gated_mix__linear_kernel_hedgehog__ssm_conv_s4__prompt_kernel,@function
gated_mix__linear_kernel_hedgehog__ssm_conv_s4__prompt_kernel:
    s_cmp_ge_u32 s2, 512
    s_cbranch_scc1 K_EXIT
    s_load_dwordx16 s[16:31], s[0:1], 0
    s_load_dwordx16 s[32:47], s[0:1], 64
    s_load_dwordx2 s[48:49], s[0:1], 128
    s_cmp_ge_u32 s2, 256
    s_cbranch_scc1 K_GEMM
    s_and_b32 s4, s2, 7
    s_lshr_b32 s5, s2, 3
    v_lshrrev_b32 v2, 6, v0
    v_and_b32 v1, 63, v0
    v_readfirstlane_b32 s6, v2
    s_lshl_b32 s9, s4, 6
    s_lshl_b32 s7, s5, 1
    s_add_u32 s9, s9, s7
    s_lshr_b32 s14, s6, 1
    s_and_b32 s10, s6, 1
    s_lshl_b32 s7, s9, 1
    s_add_u32 s9, s9, s14
    s_lshl_b32 s8, s9, 8
    s_lshl_b32 s13, s10, 7
    s_add_u32 s8, s8, s13
    v_lshlrev_b32 v2, 1, v1
    v_add_u32 v2, s8, v2
    s_lshl_b32 s3, s4, 12
    s_lshl_b32 s15, s5, 7
    s_add_u32 s3, s3, s15
    s_add_u32 s3, s3, 8519680
    s_cmp_eq_u32 s10, 0
    s_waitcnt lgkmcnt(0)
    s_cbranch_scc1 C_SN1
    s_load_dwordx16 s[84:99], s[48:49], s3 glc
C_SN1:
    s_mov_b32 s21, s3
    s_load_dword s11, s[38:39], s7
    s_load_dword s12, s[40:41], s7
    v_mov_b32 v243, 0
    global_load_ushort v20, v2, s[26:27]
    global_load_ushort v21, v2, s[28:29]
    global_load_ushort v22, v2, s[30:31]
    global_load_ushort v23, v2, s[32:33]
    global_load_ushort v24, v2, s[34:35]
    global_load_ushort v25, v2, s[36:37]
    s_mov_b32 s60, s48
    s_mov_b32 s61, s49
    s_mov_b32 s62, 0x900000
    s_mov_b32 s63, 0x20000
    s_mov_b32 s64, s46
    s_mov_b32 s65, s47
    s_mov_b32 s66, 0x100
    s_mov_b32 s67, 0x20000
    s_mov_b32 s52, s16
    s_mov_b32 s53, s17
    s_mov_b32 s54, 0x200000
    s_mov_b32 s55, 0x20000
    s_mov_b64 s[30:31], s[42:43]
    s_cmp_eq_u32 s5, 1
    s_cbranch_scc0 C_NOZ
    v_mov_b32 v152, 0
    v_mov_b32 v153, 0
    v_mov_b32 v154, 0
    v_mov_b32 v155, 0
    v_lshlrev_b32 v8, 4, v0
    s_lshl_b32 s15, s4, 13
    s_add_u32 s15, s15, 8388608
    s_add_u32 s3, s15, 4096
    buffer_store_dwordx4 v[152:155], v8, s[60:63], s15 offen sc1
    buffer_store_dwordx4 v[152:155], v8, s[60:63], s3 offen sc1
    s_cmp_eq_u32 s6, 0
    s_cbranch_scc0 C_NOZ
    s_lshl_b32 s15, s4, 9
    s_add_u32 s3, s15, 8454144
    s_mov_b32 exec_hi, 0
    buffer_store_dwordx4 v[152:155], v8, s[60:63], s3 offen sc1
    v_lshlrev_b32 v8, 8, v1
    v_lshlrev_b32 v9, 7, v1
    s_add_u32 s3, s15, 8609792
    s_mov_b64 exec, 3
    buffer_store_dword v152, v8, s[60:63], s3 offen sc1
    s_lshl_b32 s3, s15, 1
    s_add_u32 s3, s3, 8601600
    s_mov_b64 exec, 0xff
    buffer_store_dword v152, v9, s[60:63], s3 offen sc1
    s_mov_b64 exec, 0xffff
    v_lshlrev_b32 v8, 11, v1
    s_lshl_b32 s15, s4, 8
    s_add_u32 s15, s15, 8568832
    buffer_store_dword v152, v8, s[60:63], s15 offen sc1
    s_mov_b64 exec, -1
C_NOZ:
    s_cmp_eq_u32 s5, 1
    s_cbranch_scc1 C_PRZ
    s_waitcnt vmcnt(0)
C_PRZ:
    s_waitcnt vmcnt(2)
    s_waitcnt lgkmcnt(0)
    s_lshl_b32 s7, s14, 4
    s_lshr_b32 s11, s11, s7
    s_lshl_b32 s11, s11, 16
    s_lshr_b32 s12, s12, s7
    s_lshl_b32 s12, s12, 16
    v_mov_b32 v2, 0x3fb8aa3b
    v_mul_f32 v3, s11, v2
    v_exp_f32 v3, v3
    s_cmp_eq_u32 s10, 0
    s_cbranch_scc1 C_SN2
    v_writelane_b32 v240, s84, 0
    v_writelane_b32 v240, s85, 1
    v_writelane_b32 v240, s86, 2
    v_writelane_b32 v240, s87, 3
    v_writelane_b32 v240, s88, 4
    v_writelane_b32 v240, s89, 5
    v_writelane_b32 v240, s90, 6
    v_writelane_b32 v240, s91, 7
    v_writelane_b32 v240, s92, 8
    v_writelane_b32 v240, s93, 9
    v_writelane_b32 v240, s94, 10
    v_writelane_b32 v240, s95, 11
    v_writelane_b32 v240, s96, 12
    v_writelane_b32 v240, s97, 13
    v_writelane_b32 v240, s98, 14
    v_writelane_b32 v240, s99, 15
C_SN2:
    v_lshlrev_b32 v20, 16, v20
    v_lshlrev_b32 v21, 16, v21
    v_lshlrev_b32 v22, 16, v22
    v_lshlrev_b32 v23, 16, v23
    v_lshlrev_b32 v24, 16, v24
    v_lshlrev_b32 v25, 16, v25
    v_cvt_pk_bf16_f32 v3, v3, v3
    v_and_b32 v4, 0xffff0000, v3
    v_pk_mul_f32 v[20:21], v[20:21], v[4:5] op_sel_hi:[1,0]
    v_pk_mul_f32 v[22:23], v[22:23], v[4:5] op_sel_hi:[1,0]
    v_mul_f32 v28, v2, v20
    v_mul_f32 v29, 0.15915494309189532, v21
    v_mul_f32 v6, 0x3f800000, v28
    v_mul_f32 v7, 0x3f800000, v29
    v_mul_f32 v8, 0x41800000, v28
    v_mul_f32 v9, 0x41800000, v29
    v_mul_f32 v10, 0x44000000, v28
    v_mul_f32 v11, 0x44000000, v29
    v_pk_mul_f32 v[30:31], v[24:25], v[22:23] op_sel_hi:[0,1]
    v_pk_fma_f32 v[30:31], v[24:25], v[22:23], v[30:31] op_sel:[1,1,0] op_sel_hi:[1,0,1] neg_lo:[1,0,0]
    v_fract_f32 v7, v7
    v_exp_f32 v6, v6
    v_fract_f32 v9, v9
    v_exp_f32 v8, v8
    v_fract_f32 v11, v11
    v_exp_f32 v10, v10
    v_cos_f32 v32, v7
    v_sin_f32 v33, v7
    v_cos_f32 v36, v9
    v_sin_f32 v37, v9
    v_cos_f32 v42, v11
    v_sin_f32 v43, v11
    v_pk_mul_f32 v[32:33], v[32:33], v[6:7] op_sel_hi:[1,0]
    v_pk_mul_f32 v[36:37], v[36:37], v[8:9] op_sel_hi:[1,0]
    v_pk_mul_f32 v[42:43], v[42:43], v[10:11] op_sel_hi:[1,0]
    v_pk_mul_f32 v[6:7], v[32:33], v[32:33] op_sel_hi:[0,1]
    v_pk_mul_f32 v[8:9], v[36:37], v[36:37] op_sel_hi:[0,1]
    v_pk_mul_f32 v[10:11], v[42:43], v[42:43] op_sel_hi:[0,1]
    v_pk_fma_f32 v[6:7], v[32:33], v[32:33], v[6:7] op_sel:[1,1,0] op_sel_hi:[1,0,1] neg_lo:[1,0,0]
    v_pk_fma_f32 v[8:9], v[36:37], v[36:37], v[8:9] op_sel:[1,1,0] op_sel_hi:[1,0,1] neg_lo:[1,0,0]
    v_pk_fma_f32 v[10:11], v[42:43], v[42:43], v[10:11] op_sel:[1,1,0] op_sel_hi:[1,0,1] neg_lo:[1,0,0]
    v_pk_mul_f32 v[34:35], v[6:7], v[6:7] op_sel_hi:[0,1]
    v_pk_mul_f32 v[38:39], v[8:9], v[8:9] op_sel_hi:[0,1]
    v_pk_mul_f32 v[46:47], v[10:11], v[10:11] op_sel_hi:[0,1]
    v_pk_mul_f32 v[48:49], v[10:11], v[30:31] op_sel_hi:[0,1]
    v_pk_fma_f32 v[34:35], v[6:7], v[6:7], v[34:35] op_sel:[1,1,0] op_sel_hi:[1,0,1] neg_lo:[1,0,0]
    v_pk_fma_f32 v[38:39], v[8:9], v[8:9], v[38:39] op_sel:[1,1,0] op_sel_hi:[1,0,1] neg_lo:[1,0,0]
    v_pk_fma_f32 v[46:47], v[10:11], v[10:11], v[46:47] op_sel:[1,1,0] op_sel_hi:[1,0,1] neg_lo:[1,0,0]
    v_pk_fma_f32 v[48:49], v[10:11], v[30:31], v[48:49] op_sel:[1,1,0] op_sel_hi:[1,0,1] neg_lo:[1,0,0]
    v_pk_mul_f32 v[6:7], v[38:39], v[38:39] op_sel_hi:[0,1]
    v_pk_mul_f32 v[44:45], v[46:47], v[30:31] op_sel_hi:[0,1]
    v_pk_mul_f32 v[8:9], v[42:43], v[30:31] op_sel_hi:[0,1]
    v_pk_fma_f32 v[6:7], v[38:39], v[38:39], v[6:7] op_sel:[1,1,0] op_sel_hi:[1,0,1] neg_lo:[1,0,0]
    v_pk_fma_f32 v[44:45], v[46:47], v[30:31], v[44:45] op_sel:[1,1,0] op_sel_hi:[1,0,1] neg_lo:[1,0,0]
    v_pk_fma_f32 v[8:9], v[42:43], v[30:31], v[8:9] op_sel:[1,1,0] op_sel_hi:[1,0,1] neg_lo:[1,0,0]
    v_pk_mul_f32 v[10:11], v[6:7], v[6:7] op_sel_hi:[0,1]
    v_pk_fma_f32 v[10:11], v[6:7], v[6:7], v[10:11] op_sel:[1,1,0] op_sel_hi:[1,0,1] neg_lo:[1,0,0]
    v_mov_b32 v42, v8
    v_mov_b32 v43, v9
    v_pk_mul_f32 v[40:41], v[10:11], v[30:31] op_sel_hi:[0,1]
    v_pk_fma_f32 v[40:41], v[10:11], v[30:31], v[40:41] op_sel:[1,1,0] op_sel_hi:[1,0,1] neg_lo:[1,0,0]
    s_mul_i32 s7, s6, 12672
    v_lshlrev_b32 v50, 4, v1
    v_add_u32 v50, s7, v50
    v_lshrrev_b32 v6, 4, v1
    v_bfe_u32 v7, v1, 2, 2
    v_lshl_add_u32 v6, v6, 3, v7
    v_lshlrev_b32 v6, 4, v6
    v_bfe_u32 v7, v1, 1, 1
    v_mul_u32_u24 v7, 1088, v7
    v_add_u32 v6, v6, v7
    v_and_b32 v7, 1, v1
    v_lshl_add_u32 v6, v7, 3, v6
    v_add_u32 v51, s7, v6
    v_mov_b32 v52, 1.0
    v_mov_b32 v53, 0
    v_mov_b32 v72, v30
    v_mov_b32 v73, v31
    v_mov_b32 v92, v40
    v_mov_b32 v93, v41
    v_pk_mul_f32 v[54:55], v[52:53], v[32:33] op_sel_hi:[0,1]
    v_pk_mul_f32 v[74:75], v[72:73], v[36:37] op_sel_hi:[0,1]
    v_pk_mul_f32 v[94:95], v[92:93], v[36:37] op_sel_hi:[0,1]
    v_pk_fma_f32 v[54:55], v[52:53], v[32:33], v[54:55] op_sel:[1,1,0] op_sel_hi:[1,0,1] neg_lo:[1,0,0]
    v_pk_fma_f32 v[74:75], v[72:73], v[36:37], v[74:75] op_sel:[1,1,0] op_sel_hi:[1,0,1] neg_lo:[1,0,0]
    v_pk_fma_f32 v[94:95], v[92:93], v[36:37], v[94:95] op_sel:[1,1,0] op_sel_hi:[1,0,1] neg_lo:[1,0,0]
    v_cvt_pk_bf16_f32 v56, v52, v54
    v_cvt_pk_bf16_f32 v60, v53, v55
    v_cvt_pk_bf16_f32 v76, v72, v74
    v_cvt_pk_bf16_f32 v80, -v73, -v75
    v_cvt_pk_bf16_f32 v96, v92, v94
    v_cvt_pk_bf16_f32 v100, -v93, -v95
    v_pk_mul_f32 v[52:53], v[54:55], v[32:33] op_sel_hi:[0,1]
    v_pk_mul_f32 v[72:73], v[74:75], v[36:37] op_sel_hi:[0,1]
    v_pk_mul_f32 v[92:93], v[94:95], v[36:37] op_sel_hi:[0,1]
    v_pk_fma_f32 v[52:53], v[54:55], v[32:33], v[52:53] op_sel:[1,1,0] op_sel_hi:[1,0,1] neg_lo:[1,0,0]
    v_pk_fma_f32 v[72:73], v[74:75], v[36:37], v[72:73] op_sel:[1,1,0] op_sel_hi:[1,0,1] neg_lo:[1,0,0]
    v_pk_fma_f32 v[92:93], v[94:95], v[36:37], v[92:93] op_sel:[1,1,0] op_sel_hi:[1,0,1] neg_lo:[1,0,0]
    v_pk_mul_f32 v[54:55], v[52:53], v[32:33] op_sel_hi:[0,1]
    v_pk_mul_f32 v[74:75], v[72:73], v[36:37] op_sel_hi:[0,1]
    v_pk_mul_f32 v[94:95], v[92:93], v[36:37] op_sel_hi:[0,1]
    v_pk_fma_f32 v[54:55], v[52:53], v[32:33], v[54:55] op_sel:[1,1,0] op_sel_hi:[1,0,1] neg_lo:[1,0,0]
    v_pk_fma_f32 v[74:75], v[72:73], v[36:37], v[74:75] op_sel:[1,1,0] op_sel_hi:[1,0,1] neg_lo:[1,0,0]
    v_pk_fma_f32 v[94:95], v[92:93], v[36:37], v[94:95] op_sel:[1,1,0] op_sel_hi:[1,0,1] neg_lo:[1,0,0]
    v_cvt_pk_bf16_f32 v57, v52, v54
    v_cvt_pk_bf16_f32 v61, v53, v55
    v_cvt_pk_bf16_f32 v77, v72, v74
    v_cvt_pk_bf16_f32 v81, -v73, -v75
    v_cvt_pk_bf16_f32 v97, v92, v94
    v_cvt_pk_bf16_f32 v101, -v93, -v95
    v_pk_mul_f32 v[52:53], v[54:55], v[32:33] op_sel_hi:[0,1]
    v_pk_mul_f32 v[72:73], v[74:75], v[36:37] op_sel_hi:[0,1]
    v_pk_mul_f32 v[92:93], v[94:95], v[36:37] op_sel_hi:[0,1]
    v_pk_fma_f32 v[52:53], v[54:55], v[32:33], v[52:53] op_sel:[1,1,0] op_sel_hi:[1,0,1] neg_lo:[1,0,0]
    v_pk_fma_f32 v[72:73], v[74:75], v[36:37], v[72:73] op_sel:[1,1,0] op_sel_hi:[1,0,1] neg_lo:[1,0,0]
    v_pk_fma_f32 v[92:93], v[94:95], v[36:37], v[92:93] op_sel:[1,1,0] op_sel_hi:[1,0,1] neg_lo:[1,0,0]
    v_pk_mul_f32 v[54:55], v[52:53], v[32:33] op_sel_hi:[0,1]
    v_pk_mul_f32 v[74:75], v[72:73], v[36:37] op_sel_hi:[0,1]
    v_pk_mul_f32 v[94:95], v[92:93], v[36:37] op_sel_hi:[0,1]
    v_pk_fma_f32 v[54:55], v[52:53], v[32:33], v[54:55] op_sel:[1,1,0] op_sel_hi:[1,0,1] neg_lo:[1,0,0]
    v_pk_fma_f32 v[74:75], v[72:73], v[36:37], v[74:75] op_sel:[1,1,0] op_sel_hi:[1,0,1] neg_lo:[1,0,0]
    v_pk_fma_f32 v[94:95], v[92:93], v[36:37], v[94:95] op_sel:[1,1,0] op_sel_hi:[1,0,1] neg_lo:[1,0,0]
    v_cvt_pk_bf16_f32 v58, v52, v54
    v_cvt_pk_bf16_f32 v62, v53, v55
    v_cvt_pk_bf16_f32 v78, v72, v74
    v_cvt_pk_bf16_f32 v82, -v73, -v75
    v_cvt_pk_bf16_f32 v98, v92, v94
    v_cvt_pk_bf16_f32 v102, -v93, -v95
    v_pk_mul_f32 v[52:53], v[54:55], v[32:33] op_sel_hi:[0,1]
    v_pk_mul_f32 v[72:73], v[74:75], v[36:37] op_sel_hi:[0,1]
    v_pk_mul_f32 v[92:93], v[94:95], v[36:37] op_sel_hi:[0,1]
    v_pk_fma_f32 v[52:53], v[54:55], v[32:33], v[52:53] op_sel:[1,1,0] op_sel_hi:[1,0,1] neg_lo:[1,0,0]
    v_pk_fma_f32 v[72:73], v[74:75], v[36:37], v[72:73] op_sel:[1,1,0] op_sel_hi:[1,0,1] neg_lo:[1,0,0]
    v_pk_fma_f32 v[92:93], v[94:95], v[36:37], v[92:93] op_sel:[1,1,0] op_sel_hi:[1,0,1] neg_lo:[1,0,0]
    v_pk_mul_f32 v[54:55], v[52:53], v[32:33] op_sel_hi:[0,1]
    v_pk_mul_f32 v[74:75], v[72:73], v[36:37] op_sel_hi:[0,1]
    v_pk_mul_f32 v[94:95], v[92:93], v[36:37] op_sel_hi:[0,1]
    v_pk_fma_f32 v[54:55], v[52:53], v[32:33], v[54:55] op_sel:[1,1,0] op_sel_hi:[1,0,1] neg_lo:[1,0,0]
    v_pk_fma_f32 v[74:75], v[72:73], v[36:37], v[74:75] op_sel:[1,1,0] op_sel_hi:[1,0,1] neg_lo:[1,0,0]
    v_pk_fma_f32 v[94:95], v[92:93], v[36:37], v[94:95] op_sel:[1,1,0] op_sel_hi:[1,0,1] neg_lo:[1,0,0]
    v_cvt_pk_bf16_f32 v59, v52, v54
    v_cvt_pk_bf16_f32 v63, v53, v55
    v_cvt_pk_bf16_f32 v79, v72, v74
    v_cvt_pk_bf16_f32 v83, -v73, -v75
    v_cvt_pk_bf16_f32 v99, v92, v94
    v_cvt_pk_bf16_f32 v103, -v93, -v95
    v_pk_mul_f32 v[52:53], v[54:55], v[32:33] op_sel_hi:[0,1]
    v_pk_mul_f32 v[72:73], v[74:75], v[36:37] op_sel_hi:[0,1]
    v_pk_mul_f32 v[92:93], v[94:95], v[36:37] op_sel_hi:[0,1]
    v_pk_fma_f32 v[52:53], v[54:55], v[32:33], v[52:53] op_sel:[1,1,0] op_sel_hi:[1,0,1] neg_lo:[1,0,0]
    v_pk_fma_f32 v[72:73], v[74:75], v[36:37], v[72:73] op_sel:[1,1,0] op_sel_hi:[1,0,1] neg_lo:[1,0,0]
    v_pk_fma_f32 v[92:93], v[94:95], v[36:37], v[92:93] op_sel:[1,1,0] op_sel_hi:[1,0,1] neg_lo:[1,0,0]
    ds_write_b128 v50, v[56:59] offset:0
    v_pk_mul_f32 v[54:55], v[52:53], v[32:33] op_sel_hi:[0,1]
    v_pk_mul_f32 v[74:75], v[72:73], v[36:37] op_sel_hi:[0,1]
    v_pk_mul_f32 v[94:95], v[92:93], v[36:37] op_sel_hi:[0,1]
    v_pk_fma_f32 v[54:55], v[52:53], v[32:33], v[54:55] op_sel:[1,1,0] op_sel_hi:[1,0,1] neg_lo:[1,0,0]
    v_pk_fma_f32 v[74:75], v[72:73], v[36:37], v[74:75] op_sel:[1,1,0] op_sel_hi:[1,0,1] neg_lo:[1,0,0]
    v_pk_fma_f32 v[94:95], v[92:93], v[36:37], v[94:95] op_sel:[1,1,0] op_sel_hi:[1,0,1] neg_lo:[1,0,0]
    ds_write_b128 v50, v[60:63] offset:2112
    v_cvt_pk_bf16_f32 v64, v52, v54
    v_cvt_pk_bf16_f32 v68, v53, v55
    v_cvt_pk_bf16_f32 v84, v72, v74
    v_cvt_pk_bf16_f32 v88, -v73, -v75
    v_cvt_pk_bf16_f32 v104, v92, v94
    v_cvt_pk_bf16_f32 v108, -v93, -v95
    v_pk_mul_f32 v[52:53], v[54:55], v[32:33] op_sel_hi:[0,1]
    v_pk_mul_f32 v[72:73], v[74:75], v[36:37] op_sel_hi:[0,1]
    v_pk_mul_f32 v[92:93], v[94:95], v[36:37] op_sel_hi:[0,1]
    v_pk_fma_f32 v[52:53], v[54:55], v[32:33], v[52:53] op_sel:[1,1,0] op_sel_hi:[1,0,1] neg_lo:[1,0,0]
    v_pk_fma_f32 v[72:73], v[74:75], v[36:37], v[72:73] op_sel:[1,1,0] op_sel_hi:[1,0,1] neg_lo:[1,0,0]
    v_pk_fma_f32 v[92:93], v[94:95], v[36:37], v[92:93] op_sel:[1,1,0] op_sel_hi:[1,0,1] neg_lo:[1,0,0]
    ds_write_b128 v50, v[76:79] offset:4224
    v_pk_mul_f32 v[54:55], v[52:53], v[32:33] op_sel_hi:[0,1]
    v_pk_mul_f32 v[74:75], v[72:73], v[36:37] op_sel_hi:[0,1]
    v_pk_mul_f32 v[94:95], v[92:93], v[36:37] op_sel_hi:[0,1]
    v_pk_fma_f32 v[54:55], v[52:53], v[32:33], v[54:55] op_sel:[1,1,0] op_sel_hi:[1,0,1] neg_lo:[1,0,0]
    v_pk_fma_f32 v[74:75], v[72:73], v[36:37], v[74:75] op_sel:[1,1,0] op_sel_hi:[1,0,1] neg_lo:[1,0,0]
    v_pk_fma_f32 v[94:95], v[92:93], v[36:37], v[94:95] op_sel:[1,1,0] op_sel_hi:[1,0,1] neg_lo:[1,0,0]
    ds_write_b128 v50, v[80:83] offset:6336
    v_cvt_pk_bf16_f32 v65, v52, v54
    v_cvt_pk_bf16_f32 v69, v53, v55
    v_cvt_pk_bf16_f32 v85, v72, v74
    v_cvt_pk_bf16_f32 v89, -v73, -v75
    v_cvt_pk_bf16_f32 v105, v92, v94
    v_cvt_pk_bf16_f32 v109, -v93, -v95
    v_pk_mul_f32 v[52:53], v[54:55], v[32:33] op_sel_hi:[0,1]
    v_pk_mul_f32 v[72:73], v[74:75], v[36:37] op_sel_hi:[0,1]
    v_pk_mul_f32 v[92:93], v[94:95], v[36:37] op_sel_hi:[0,1]
    v_pk_fma_f32 v[52:53], v[54:55], v[32:33], v[52:53] op_sel:[1,1,0] op_sel_hi:[1,0,1] neg_lo:[1,0,0]
    v_pk_fma_f32 v[72:73], v[74:75], v[36:37], v[72:73] op_sel:[1,1,0] op_sel_hi:[1,0,1] neg_lo:[1,0,0]
    v_pk_fma_f32 v[92:93], v[94:95], v[36:37], v[92:93] op_sel:[1,1,0] op_sel_hi:[1,0,1] neg_lo:[1,0,0]
    ds_write_b128 v50, v[96:99] offset:8448
    v_pk_mul_f32 v[54:55], v[52:53], v[32:33] op_sel_hi:[0,1]
    v_pk_mul_f32 v[74:75], v[72:73], v[36:37] op_sel_hi:[0,1]
    v_pk_mul_f32 v[94:95], v[92:93], v[36:37] op_sel_hi:[0,1]
    v_pk_fma_f32 v[54:55], v[52:53], v[32:33], v[54:55] op_sel:[1,1,0] op_sel_hi:[1,0,1] neg_lo:[1,0,0]
    v_pk_fma_f32 v[74:75], v[72:73], v[36:37], v[74:75] op_sel:[1,1,0] op_sel_hi:[1,0,1] neg_lo:[1,0,0]
    v_pk_fma_f32 v[94:95], v[92:93], v[36:37], v[94:95] op_sel:[1,1,0] op_sel_hi:[1,0,1] neg_lo:[1,0,0]
    ds_write_b128 v50, v[100:103] offset:10560
    v_cvt_pk_bf16_f32 v66, v52, v54
    v_cvt_pk_bf16_f32 v70, v53, v55
    v_cvt_pk_bf16_f32 v86, v72, v74
    v_cvt_pk_bf16_f32 v90, -v73, -v75
    v_cvt_pk_bf16_f32 v106, v92, v94
    v_cvt_pk_bf16_f32 v110, -v93, -v95
    v_pk_mul_f32 v[52:53], v[54:55], v[32:33] op_sel_hi:[0,1]
    v_pk_mul_f32 v[72:73], v[74:75], v[36:37] op_sel_hi:[0,1]
    v_pk_mul_f32 v[92:93], v[94:95], v[36:37] op_sel_hi:[0,1]
    v_pk_fma_f32 v[52:53], v[54:55], v[32:33], v[52:53] op_sel:[1,1,0] op_sel_hi:[1,0,1] neg_lo:[1,0,0]
    v_pk_fma_f32 v[72:73], v[74:75], v[36:37], v[72:73] op_sel:[1,1,0] op_sel_hi:[1,0,1] neg_lo:[1,0,0]
    v_pk_fma_f32 v[92:93], v[94:95], v[36:37], v[92:93] op_sel:[1,1,0] op_sel_hi:[1,0,1] neg_lo:[1,0,0]
    v_pk_mul_f32 v[54:55], v[52:53], v[32:33] op_sel_hi:[0,1]
    v_pk_mul_f32 v[74:75], v[72:73], v[36:37] op_sel_hi:[0,1]
    v_pk_mul_f32 v[94:95], v[92:93], v[36:37] op_sel_hi:[0,1]
    v_pk_fma_f32 v[54:55], v[52:53], v[32:33], v[54:55] op_sel:[1,1,0] op_sel_hi:[1,0,1] neg_lo:[1,0,0]
    v_pk_fma_f32 v[74:75], v[72:73], v[36:37], v[74:75] op_sel:[1,1,0] op_sel_hi:[1,0,1] neg_lo:[1,0,0]
    v_pk_fma_f32 v[94:95], v[92:93], v[36:37], v[94:95] op_sel:[1,1,0] op_sel_hi:[1,0,1] neg_lo:[1,0,0]
    v_cvt_pk_bf16_f32 v67, v52, v54
    v_cvt_pk_bf16_f32 v71, v53, v55
    v_cvt_pk_bf16_f32 v87, v72, v74
    v_cvt_pk_bf16_f32 v91, -v73, -v75
    v_cvt_pk_bf16_f32 v107, v92, v94
    v_cvt_pk_bf16_f32 v111, -v93, -v95
    v_mov_b32 v52, 1.0
    v_mov_b32 v53, 0
    v_mov_b32 v92, v48
    v_mov_b32 v93, v49
    ds_write_b128 v50, v[64:67] offset:1088
    v_cvt_pk_bf16_f32 v76, v44, v44
    v_cvt_pk_bf16_f32 v80, -v45, -v45
    v_mov_b32 v77, 0
    v_mov_b32 v78, 0
    v_mov_b32 v79, 0
    v_mov_b32 v81, 0
    v_mov_b32 v82, 0
    v_mov_b32 v83, 0
    s_cmp_eq_u32 s5, 1
    s_cbranch_scc0 C_NOPUB
    s_waitcnt vmcnt(0)
    s_barrier
    s_lshl_b32 s7, s4, 2
    v_mov_b32 v13, 1
    s_cmp_eq_u32 s6, 0
    s_cbranch_scc0 C_NOPUB
    s_mov_b64 exec, 1
    buffer_store_dword v13, v243, s[64:67], s7 offen offset:128 sc1
    s_mov_b64 exec, -1
C_NOPUB:
    v_pk_mul_f32 v[54:55], v[52:53], v[34:35] op_sel_hi:[0,1]
    v_pk_mul_f32 v[94:95], v[92:93], v[38:39] op_sel_hi:[0,1]
    ds_write_b128 v50, v[68:71] offset:3200
    v_pk_fma_f32 v[54:55], v[52:53], v[34:35], v[54:55] op_sel:[1,1,0] op_sel_hi:[1,0,1] neg_lo:[1,0,0]
    v_pk_fma_f32 v[94:95], v[92:93], v[38:39], v[94:95] op_sel:[1,1,0] op_sel_hi:[1,0,1] neg_lo:[1,0,0]
    s_cmp_eq_u32 s10, 0
    s_cbranch_scc0 C_SKG
    s_lshl_b32 s28, s4, 8
    s_lshl_b32 s7, s5, 3
    s_add_u32 s28, s28, s7
    s_lshl_b32 s7, s14, 2
    s_add_u32 s28, s28, s7
    s_lshl_b32 s7, s28, 10
    v_and_b32 v12, 31, v1
    v_lshlrev_b32 v12, 5, v12
    v_lshrrev_b32 v13, 5, v1
    v_lshl_add_u32 v13, v13, 10, v12
    global_load_dwordx4 v[208:211], v12, s[30:31]
    global_load_dwordx4 v[212:215], v12, s[30:31] offset:16
    buffer_load_dwordx4 v[216:219], v13, s[52:55], s7 offen
    buffer_load_dwordx4 v[220:223], v13, s[52:55], s7 offen offset:16
    buffer_load_dwordx4 v[224:227], v13, s[52:55], s7 offen offset:2048
    buffer_load_dwordx4 v[228:231], v13, s[52:55], s7 offen offset:2064
C_SKG:
    v_cvt_pk_bf16_f32 v56, v52, v54
    v_cvt_pk_bf16_f32 v60, v53, v55
    v_cvt_pk_bf16_f32 v96, v92, v94
    v_cvt_pk_bf16_f32 v100, -v93, -v95
    v_pk_mul_f32 v[52:53], v[54:55], v[34:35] op_sel_hi:[0,1]
    v_pk_mul_f32 v[92:93], v[94:95], v[38:39] op_sel_hi:[0,1]
    v_pk_fma_f32 v[52:53], v[54:55], v[34:35], v[52:53] op_sel:[1,1,0] op_sel_hi:[1,0,1] neg_lo:[1,0,0]
    v_pk_fma_f32 v[92:93], v[94:95], v[38:39], v[92:93] op_sel:[1,1,0] op_sel_hi:[1,0,1] neg_lo:[1,0,0]
    ds_write_b128 v50, v[84:87] offset:5312
    v_pk_mul_f32 v[54:55], v[52:53], v[34:35] op_sel_hi:[0,1]
    v_pk_mul_f32 v[94:95], v[92:93], v[38:39] op_sel_hi:[0,1]
    v_pk_fma_f32 v[54:55], v[52:53], v[34:35], v[54:55] op_sel:[1,1,0] op_sel_hi:[1,0,1] neg_lo:[1,0,0]
    v_pk_fma_f32 v[94:95], v[92:93], v[38:39], v[94:95] op_sel:[1,1,0] op_sel_hi:[1,0,1] neg_lo:[1,0,0]
    ds_write_b128 v50, v[88:91] offset:7424
    v_cvt_pk_bf16_f32 v57, v52, v54
    v_cvt_pk_bf16_f32 v61, v53, v55
    v_cvt_pk_bf16_f32 v97, v92, v94
    v_cvt_pk_bf16_f32 v101, -v93, -v95
    v_pk_mul_f32 v[52:53], v[54:55], v[34:35] op_sel_hi:[0,1]
    v_pk_mul_f32 v[92:93], v[94:95], v[38:39] op_sel_hi:[0,1]
    v_pk_fma_f32 v[52:53], v[54:55], v[34:35], v[52:53] op_sel:[1,1,0] op_sel_hi:[1,0,1] neg_lo:[1,0,0]
    v_pk_fma_f32 v[92:93], v[94:95], v[38:39], v[92:93] op_sel:[1,1,0] op_sel_hi:[1,0,1] neg_lo:[1,0,0]
    ds_write_b128 v50, v[104:107] offset:9536
    v_pk_mul_f32 v[54:55], v[52:53], v[34:35] op_sel_hi:[0,1]
    v_pk_mul_f32 v[94:95], v[92:93], v[38:39] op_sel_hi:[0,1]
    v_pk_fma_f32 v[54:55], v[52:53], v[34:35], v[54:55] op_sel:[1,1,0] op_sel_hi:[1,0,1] neg_lo:[1,0,0]
    v_pk_fma_f32 v[94:95], v[92:93], v[38:39], v[94:95] op_sel:[1,1,0] op_sel_hi:[1,0,1] neg_lo:[1,0,0]
    ds_write_b128 v50, v[108:111] offset:11648
    v_cvt_pk_bf16_f32 v58, v52, v54
    v_cvt_pk_bf16_f32 v62, v53, v55
    v_cvt_pk_bf16_f32 v98, v92, v94
    v_cvt_pk_bf16_f32 v102, -v93, -v95
    v_pk_mul_f32 v[52:53], v[54:55], v[34:35] op_sel_hi:[0,1]
    v_pk_mul_f32 v[92:93], v[94:95], v[38:39] op_sel_hi:[0,1]
    v_pk_fma_f32 v[52:53], v[54:55], v[34:35], v[52:53] op_sel:[1,1,0] op_sel_hi:[1,0,1] neg_lo:[1,0,0]
    v_pk_fma_f32 v[92:93], v[94:95], v[38:39], v[92:93] op_sel:[1,1,0] op_sel_hi:[1,0,1] neg_lo:[1,0,0]
    ds_read_b64_tr_b16 v[128:129], v51 offset:0
    ds_read_b64_tr_b16 v[130:131], v51 offset:64
    ds_read_b64_tr_b16 v[132:133], v51 offset:4224
    ds_read_b64_tr_b16 v[134:135], v51 offset:4288
    ds_read_b64_tr_b16 v[136:137], v51 offset:8448
    ds_read_b64_tr_b16 v[138:139], v51 offset:8512
    v_pk_mul_f32 v[54:55], v[52:53], v[34:35] op_sel_hi:[0,1]
    v_pk_mul_f32 v[94:95], v[92:93], v[38:39] op_sel_hi:[0,1]
    v_pk_fma_f32 v[54:55], v[52:53], v[34:35], v[54:55] op_sel:[1,1,0] op_sel_hi:[1,0,1] neg_lo:[1,0,0]
    v_pk_fma_f32 v[94:95], v[92:93], v[38:39], v[94:95] op_sel:[1,1,0] op_sel_hi:[1,0,1] neg_lo:[1,0,0]
    ds_read_b64_tr_b16 v[140:141], v51 offset:2112
    ds_read_b64_tr_b16 v[142:143], v51 offset:2176
    ds_read_b64_tr_b16 v[144:145], v51 offset:6336
    ds_read_b64_tr_b16 v[146:147], v51 offset:6400
    ds_read_b64_tr_b16 v[148:149], v51 offset:10560
    ds_read_b64_tr_b16 v[150:151], v51 offset:10624
    v_cvt_pk_bf16_f32 v59, v52, v54
    v_cvt_pk_bf16_f32 v63, v53, v55
    v_cvt_pk_bf16_f32 v99, v92, v94
    v_cvt_pk_bf16_f32 v103, -v93, -v95
    v_pk_mul_f32 v[52:53], v[54:55], v[34:35] op_sel_hi:[0,1]
    v_mov_b32 v72, v42
    v_mov_b32 v73, v43
    v_pk_mul_f32 v[92:93], v[94:95], v[38:39] op_sel_hi:[0,1]
    ds_read_b64_tr_b16 v[152:153], v51 offset:512
    ds_read_b64_tr_b16 v[154:155], v51 offset:576
    ds_read_b64_tr_b16 v[156:157], v51 offset:4736
    ds_read_b64_tr_b16 v[158:159], v51 offset:4800
    ds_read_b64_tr_b16 v[160:161], v51 offset:8960
    ds_read_b64_tr_b16 v[162:163], v51 offset:9024
    v_pk_fma_f32 v[52:53], v[54:55], v[34:35], v[52:53] op_sel:[1,1,0] op_sel_hi:[1,0,1] neg_lo:[1,0,0]
    v_pk_fma_f32 v[92:93], v[94:95], v[38:39], v[92:93] op_sel:[1,1,0] op_sel_hi:[1,0,1] neg_lo:[1,0,0]
    s_waitcnt lgkmcnt(12)
    v_mfma_f32_16x16x32_bf16 v[112:115], v[128:131], v[132:135], 0
    v_mfma_f32_16x16x32_bf16 v[116:119], v[128:131], v[136:139], 0
    v_pk_mul_f32 v[54:55], v[52:53], v[34:35] op_sel_hi:[0,1]
    v_pk_mul_f32 v[74:75], v[72:73], v[38:39] op_sel_hi:[0,1]
    v_pk_mul_f32 v[94:95], v[92:93], v[38:39] op_sel_hi:[0,1]
    ds_read_b64_tr_b16 v[164:165], v51 offset:2624
    ds_read_b64_tr_b16 v[166:167], v51 offset:2688
    ds_read_b64_tr_b16 v[168:169], v51 offset:6848
    ds_read_b64_tr_b16 v[170:171], v51 offset:6912
    ds_read_b64_tr_b16 v[172:173], v51 offset:11072
    ds_read_b64_tr_b16 v[174:175], v51 offset:11136
    v_pk_fma_f32 v[54:55], v[52:53], v[34:35], v[54:55] op_sel:[1,1,0] op_sel_hi:[1,0,1] neg_lo:[1,0,0]
    v_pk_fma_f32 v[74:75], v[72:73], v[38:39], v[74:75] op_sel:[1,1,0] op_sel_hi:[1,0,1] neg_lo:[1,0,0]
    v_pk_fma_f32 v[94:95], v[92:93], v[38:39], v[94:95] op_sel:[1,1,0] op_sel_hi:[1,0,1] neg_lo:[1,0,0]
    s_waitcnt lgkmcnt(12)
    v_mfma_f32_16x16x32_bf16 v[112:115], v[140:143], v[144:147], v[112:115]
    v_mfma_f32_16x16x32_bf16 v[116:119], v[140:143], v[148:151], v[116:119]
    v_cvt_pk_bf16_f32 v64, v52, v54
    v_cvt_pk_bf16_f32 v68, v53, v55
    v_cvt_pk_bf16_f32 v84, v72, v74
    v_cvt_pk_bf16_f32 v88, -v73, -v75
    v_cvt_pk_bf16_f32 v104, v92, v94
    v_cvt_pk_bf16_f32 v108, -v93, -v95
    v_pk_mul_f32 v[52:53], v[54:55], v[34:35] op_sel_hi:[0,1]
    v_pk_mul_f32 v[72:73], v[74:75], v[38:39] op_sel_hi:[0,1]
    v_pk_mul_f32 v[92:93], v[94:95], v[38:39] op_sel_hi:[0,1]
    s_waitcnt lgkmcnt(6)
    v_mfma_f32_16x16x32_bf16 v[112:115], v[152:155], v[156:159], v[112:115]
    v_mfma_f32_16x16x32_bf16 v[116:119], v[152:155], v[160:163], v[116:119]
    v_pk_fma_f32 v[52:53], v[54:55], v[34:35], v[52:53] op_sel:[1,1,0] op_sel_hi:[1,0,1] neg_lo:[1,0,0]
    v_pk_fma_f32 v[72:73], v[74:75], v[38:39], v[72:73] op_sel:[1,1,0] op_sel_hi:[1,0,1] neg_lo:[1,0,0]
    v_pk_fma_f32 v[92:93], v[94:95], v[38:39], v[92:93] op_sel:[1,1,0] op_sel_hi:[1,0,1] neg_lo:[1,0,0]
    ds_write_b128 v50, v[56:59] offset:0
    s_cmp_eq_u32 s10, 0
    s_cbranch_scc1 C_SKP
    s_load_dwordx16 s[32:47], s[48:49], s21 glc
C_SKP:
    v_pk_mul_f32 v[54:55], v[52:53], v[34:35] op_sel_hi:[0,1]
    v_pk_mul_f32 v[74:75], v[72:73], v[38:39] op_sel_hi:[0,1]
    v_pk_mul_f32 v[94:95], v[92:93], v[38:39] op_sel_hi:[0,1]
    s_waitcnt lgkmcnt(1)
    v_mfma_f32_16x16x32_bf16 v[112:115], v[164:167], v[168:171], v[112:115]
    v_mfma_f32_16x16x32_bf16 v[116:119], v[164:167], v[172:175], v[116:119]
    v_pk_fma_f32 v[54:55], v[52:53], v[34:35], v[54:55] op_sel:[1,1,0] op_sel_hi:[1,0,1] neg_lo:[1,0,0]
    v_pk_fma_f32 v[74:75], v[72:73], v[38:39], v[74:75] op_sel:[1,1,0] op_sel_hi:[1,0,1] neg_lo:[1,0,0]
    v_pk_fma_f32 v[94:95], v[92:93], v[38:39], v[94:95] op_sel:[1,1,0] op_sel_hi:[1,0,1] neg_lo:[1,0,0]
    ds_write_b128 v50, v[60:63] offset:2112
    v_cvt_pk_bf16_f32 v65, v52, v54
    v_cvt_pk_bf16_f32 v69, v53, v55
    v_cvt_pk_bf16_f32 v85, v72, v74
    v_cvt_pk_bf16_f32 v89, -v73, -v75
    v_cvt_pk_bf16_f32 v105, v92, v94
    v_cvt_pk_bf16_f32 v109, -v93, -v95
    v_pk_mul_f32 v[52:53], v[54:55], v[34:35] op_sel_hi:[0,1]
    v_pk_mul_f32 v[72:73], v[74:75], v[38:39] op_sel_hi:[0,1]
    v_pk_mul_f32 v[92:93], v[94:95], v[38:39] op_sel_hi:[0,1]
    v_pk_fma_f32 v[52:53], v[54:55], v[34:35], v[52:53] op_sel:[1,1,0] op_sel_hi:[1,0,1] neg_lo:[1,0,0]
    v_pk_fma_f32 v[72:73], v[74:75], v[38:39], v[72:73] op_sel:[1,1,0] op_sel_hi:[1,0,1] neg_lo:[1,0,0]
    v_pk_fma_f32 v[92:93], v[94:95], v[38:39], v[92:93] op_sel:[1,1,0] op_sel_hi:[1,0,1] neg_lo:[1,0,0]
    ds_write_b128 v50, v[76:79] offset:4224
    v_pk_mul_f32 v[54:55], v[52:53], v[34:35] op_sel_hi:[0,1]
    v_pk_mul_f32 v[74:75], v[72:73], v[38:39] op_sel_hi:[0,1]
    v_pk_mul_f32 v[94:95], v[92:93], v[38:39] op_sel_hi:[0,1]
    v_pk_fma_f32 v[54:55], v[52:53], v[34:35], v[54:55] op_sel:[1,1,0] op_sel_hi:[1,0,1] neg_lo:[1,0,0]
    v_pk_fma_f32 v[74:75], v[72:73], v[38:39], v[74:75] op_sel:[1,1,0] op_sel_hi:[1,0,1] neg_lo:[1,0,0]
    v_pk_fma_f32 v[94:95], v[92:93], v[38:39], v[94:95] op_sel:[1,1,0] op_sel_hi:[1,0,1] neg_lo:[1,0,0]
    ds_write_b128 v50, v[80:83] offset:6336
    v_cvt_pk_bf16_f32 v66, v52, v54
    v_cvt_pk_bf16_f32 v70, v53, v55
    v_cvt_pk_bf16_f32 v86, v72, v74
    v_cvt_pk_bf16_f32 v90, -v73, -v75
    v_cvt_pk_bf16_f32 v106, v92, v94
    v_cvt_pk_bf16_f32 v110, -v93, -v95
    v_pk_mul_f32 v[52:53], v[54:55], v[34:35] op_sel_hi:[0,1]
    v_pk_mul_f32 v[72:73], v[74:75], v[38:39] op_sel_hi:[0,1]
    v_pk_mul_f32 v[92:93], v[94:95], v[38:39] op_sel_hi:[0,1]
    v_pk_fma_f32 v[52:53], v[54:55], v[34:35], v[52:53] op_sel:[1,1,0] op_sel_hi:[1,0,1] neg_lo:[1,0,0]
    v_pk_fma_f32 v[72:73], v[74:75], v[38:39], v[72:73] op_sel:[1,1,0] op_sel_hi:[1,0,1] neg_lo:[1,0,0]
    v_pk_fma_f32 v[92:93], v[94:95], v[38:39], v[92:93] op_sel:[1,1,0] op_sel_hi:[1,0,1] neg_lo:[1,0,0]
    ds_write_b128 v50, v[96:99] offset:8448
    v_pk_mul_f32 v[54:55], v[52:53], v[34:35] op_sel_hi:[0,1]
    v_pk_mul_f32 v[74:75], v[72:73], v[38:39] op_sel_hi:[0,1]
    v_pk_mul_f32 v[94:95], v[92:93], v[38:39] op_sel_hi:[0,1]
    v_pk_fma_f32 v[54:55], v[52:53], v[34:35], v[54:55] op_sel:[1,1,0] op_sel_hi:[1,0,1] neg_lo:[1,0,0]
    v_pk_fma_f32 v[74:75], v[72:73], v[38:39], v[74:75] op_sel:[1,1,0] op_sel_hi:[1,0,1] neg_lo:[1,0,0]
    v_pk_fma_f32 v[94:95], v[92:93], v[38:39], v[94:95] op_sel:[1,1,0] op_sel_hi:[1,0,1] neg_lo:[1,0,0]
    ds_write_b128 v50, v[100:103] offset:10560
    v_cvt_pk_bf16_f32 v67, v52, v54
    v_cvt_pk_bf16_f32 v71, v53, v55
    v_cvt_pk_bf16_f32 v87, v72, v74
    v_cvt_pk_bf16_f32 v91, -v73, -v75
    v_cvt_pk_bf16_f32 v107, v92, v94
    v_cvt_pk_bf16_f32 v111, -v93, -v95
    ds_write_b128 v50, v[64:67] offset:1088
    ds_write_b128 v50, v[68:71] offset:3200
    ds_write_b128 v50, v[84:87] offset:5312
    ds_write_b128 v50, v[88:91] offset:7424
    ds_write_b128 v50, v[104:107] offset:9536
    ds_write_b128 v50, v[108:111] offset:11648
    ds_read_b64_tr_b16 v[128:129], v51 offset:0
    ds_read_b64_tr_b16 v[130:131], v51 offset:64
    ds_read_b64_tr_b16 v[132:133], v51 offset:4224
    ds_read_b64_tr_b16 v[134:135], v51 offset:4288
    ds_read_b64_tr_b16 v[136:137], v51 offset:8448
    ds_read_b64_tr_b16 v[138:139], v51 offset:8512
    s_waitcnt lgkmcnt(8)
    ds_read_b64_tr_b16 v[140:141], v51 offset:2112
    ds_read_b64_tr_b16 v[142:143], v51 offset:2176
    ds_read_b64_tr_b16 v[144:145], v51 offset:6336
    ds_read_b64_tr_b16 v[146:147], v51 offset:6400
    ds_read_b64_tr_b16 v[148:149], v51 offset:10560
    ds_read_b64_tr_b16 v[150:151], v51 offset:10624
    s_waitcnt lgkmcnt(6)
    v_mfma_f32_16x16x32_bf16 v[120:123], v[132:135], v[128:131], 0
    v_mfma_f32_16x16x32_bf16 v[124:127], v[136:139], v[128:131], 0
    ds_read_b64_tr_b16 v[152:153], v51 offset:512
    ds_read_b64_tr_b16 v[154:155], v51 offset:576
    ds_read_b64_tr_b16 v[156:157], v51 offset:4736
    ds_read_b64_tr_b16 v[158:159], v51 offset:4800
    ds_read_b64_tr_b16 v[160:161], v51 offset:8960
    ds_read_b64_tr_b16 v[162:163], v51 offset:9024
    s_waitcnt lgkmcnt(6)
    v_mfma_f32_16x16x32_bf16 v[120:123], v[144:147], v[140:143], v[120:123]
    v_mfma_f32_16x16x32_bf16 v[124:127], v[148:151], v[140:143], v[124:127]
    ds_read_b64_tr_b16 v[164:165], v51 offset:2624
    ds_read_b64_tr_b16 v[166:167], v51 offset:2688
    ds_read_b64_tr_b16 v[168:169], v51 offset:6848
    ds_read_b64_tr_b16 v[170:171], v51 offset:6912
    ds_read_b64_tr_b16 v[172:173], v51 offset:11072
    ds_read_b64_tr_b16 v[174:175], v51 offset:11136
    s_waitcnt lgkmcnt(6)
    v_mfma_f32_16x16x32_bf16 v[120:123], v[156:159], v[152:155], v[120:123]
    v_mfma_f32_16x16x32_bf16 v[124:127], v[160:163], v[152:155], v[124:127]
    s_waitcnt lgkmcnt(0)
    v_mfma_f32_16x16x32_bf16 v[120:123], v[168:171], v[164:167], v[120:123]
    v_mfma_f32_16x16x32_bf16 v[124:127], v[172:175], v[164:167], v[124:127]
    s_cmp_eq_u32 s10, 0
    s_cbranch_scc1 C_EV1
    s_nop 5
    ds_write_b128 v50, v[112:115] offset:0
    ds_write_b128 v50, v[116:119] offset:1024
    ds_write_b128 v50, v[120:123] offset:2048
    ds_write_b128 v50, v[124:127] offset:3072
    s_waitcnt lgkmcnt(0)
C_EV1:
    s_setprio 3
    s_barrier
    s_cmp_eq_u32 s10, 0
    s_cbranch_scc1 C_EXP
    s_mov_b32 s8, 0
    s_lshl_b32 s13, s4, 2
C_POLL:
    s_waitcnt lgkmcnt(0)
    v_writelane_b32 v11, s32, 0
    v_writelane_b32 v11, s33, 1
    v_writelane_b32 v11, s34, 2
    v_writelane_b32 v11, s35, 3
    v_writelane_b32 v11, s36, 4
    v_writelane_b32 v11, s37, 5
    v_writelane_b32 v11, s38, 6
    v_writelane_b32 v11, s39, 7
    v_writelane_b32 v11, s40, 8
    v_writelane_b32 v11, s41, 9
    v_writelane_b32 v11, s42, 10
    v_writelane_b32 v11, s43, 11
    v_writelane_b32 v11, s44, 12
    v_writelane_b32 v11, s45, 13
    v_writelane_b32 v11, s46, 14
    v_writelane_b32 v11, s47, 15
    v_cmp_eq_u32 vcc, v240, v11
    s_nop 1
    s_and_b32 s7, vcc_lo, 0xffff
    s_cbranch_scc0 C_POLLOK
    s_add_u32 s8, s8, 1
    s_cmp_gt_u32 s8, 100000
    s_cbranch_scc1 C_POLLOK
    s_and_b32 s7, s8, 7
    s_cmp_eq_u32 s7, 0
    s_cbranch_scc0 C_PNF
    v_and_b32 v12, 7, v1
    v_lshlrev_b32 v12, 2, v12
    buffer_load_dword v11, v12, s[64:67], 0 offen offset:128 sc1
    s_waitcnt vmcnt(0)
    v_cmp_eq_u32 vcc, 0, v11
    s_nop 1
    s_cbranch_vccnz C_PNF
    v_and_b32 v12, 15, v1
    v_lshlrev_b32 v12, 8, v12
    s_mov_b32 s7, 8609792
    buffer_load_dword v11, v12, s[60:63], s7 offen sc1
    s_waitcnt vmcnt(0)
    v_cmp_ne_u32 vcc, 16, v11
    s_nop 1
    s_cbranch_vccz C_POLLOK
C_PNF:
    s_sleep 2
    s_load_dwordx16 s[32:47], s[48:49], s21 glc
    s_branch C_POLL
C_POLLOK:
    s_lshl_b32 s7, s9, 12
    v_lshlrev_b32 v11, 4, v1
    buffer_load_dwordx4 v[152:155], v11, s[60:63], s7 offen offset:0 sc1
    buffer_load_dwordx4 v[156:159], v11, s[60:63], s7 offen offset:1024 sc1
    buffer_load_dwordx4 v[160:163], v11, s[60:63], s7 offen offset:2048 sc1
    buffer_load_dwordx4 v[164:167], v11, s[60:63], s7 offen offset:3072 sc1
    s_mul_i32 s7, s14, 4608
    s_add_u32 s7, s7, 67328
    v_add_u32 v11, s7, v11
    v_lshlrev_b32 v12, 3, v1
    v_add_u32 v12, s7, v12
    v_mov_b32 v14, 0
    v_mov_b32 v15, 0
    ds_write_b64 v12, v[14:15]
    s_waitcnt vmcnt(3)
    ds_write_b128 v11, v[152:155] offset:512
    s_waitcnt vmcnt(2)
    ds_write_b128 v11, v[156:159] offset:1536
    s_waitcnt vmcnt(1)
    ds_write_b128 v11, v[160:163] offset:2560
    s_waitcnt vmcnt(0)
    ds_write_b128 v11, v[164:167] offset:3584
    s_branch C_EXPD
C_EXP:
    ds_read_b128 v[128:131], v50 offset:12672
    ds_read_b128 v[132:135], v50 offset:13696
    ds_read_b128 v[136:139], v50 offset:14720
    ds_read_b128 v[140:143], v50 offset:15744
    s_mul_i32 s7, s14, 8320
    s_add_u32 s7, s7, 50688
    v_and_b32 v8, 15, v1
    v_lshrrev_b32 v9, 4, v1
    v_lshl_add_u32 v12, v8, 2, v9
    v_sub_u32 v12, 63, v12
    v_lshlrev_b32 v12, 3, v12
    v_add_u32 v12, s7, v12
    v_lshl_add_u32 v13, v9, 6, v8
    v_sub_u32 v13, 207, v13
    v_lshlrev_b32 v13, 3, v13
    v_add_u32 v13, s7, v13
    v_mov_b32 v14, 0
    v_mov_b32 v15, 0
    v_mov_b32 v16, 0
    v_mov_b32 v17, 0
    v_mov_b32 v18, s7
    v_mov_b32 v19, 0
    s_mov_b32 s18, 0xaaaaaaaa
    s_mov_b32 s19, 0xaaaaaaaa
    s_mov_b32 s22, 0x88888888
    s_mov_b32 s23, 0x88888888
    s_mov_b64 exec, 1
    v_mov_b32 v19, s12
    ds_write_b128 v18, v[14:17] offset:4096
    ds_write_b128 v18, v[14:17] offset:4112
    ds_write_b128 v18, v[14:17] offset:8256
    ds_write_b128 v18, v[14:17] offset:8272
    ds_write_b32 v18, v14 offset:4092
    s_mov_b64 exec, -1
    s_waitcnt lgkmcnt(5)
    v_pk_add_f32 v[112:113], v[112:113], v[128:129]
    v_pk_add_f32 v[114:115], v[114:115], v[130:131]
    v_pk_add_f32 v[116:117], v[116:117], v[132:133]
    v_pk_add_f32 v[118:119], v[118:119], v[134:135]
    v_pk_add_f32 v[120:121], v[120:121], v[136:137]
    v_pk_add_f32 v[122:123], v[122:123], v[138:139]
    v_pk_add_f32 v[124:125], v[124:125], v[140:141]
    v_pk_add_f32 v[126:127], v[126:127], v[142:143]
    v_add_f32 v112, v112, v19
    v_readlane_b32 s8, v120, 0
    v_readlane_b32 s13, v124, 0
    v_mov_b32_dpp v144, v121 row_ror:15 row_mask:0xf bank_mask:0xf
    v_mov_b32_dpp v145, v122 row_ror:15 row_mask:0xf bank_mask:0xf
    v_mov_b32_dpp v146, v123 row_ror:15 row_mask:0xf bank_mask:0xf
    v_mov_b32_dpp v147, v120 wave_shl:1 row_mask:0xf bank_mask:0xf
    v_mov_b32_dpp v148, v125 row_ror:15 row_mask:0xf bank_mask:0xf
    v_mov_b32_dpp v149, v126 row_ror:15 row_mask:0xf bank_mask:0xf
    v_mov_b32_dpp v150, v127 row_ror:15 row_mask:0xf bank_mask:0xf
    v_mov_b32_dpp v151, v124 wave_shl:1 row_mask:0xf bank_mask:0xf
    v_writelane_b32 v147, s13, 63
    v_writelane_b32 v151, s8, 63
    v_mov_b32_dpp v144, v120 row_shl:1 row_mask:0xf bank_mask:0xf
    v_mov_b32_dpp v145, v121 row_shl:1 row_mask:0xf bank_mask:0xf
    v_mov_b32_dpp v146, v122 row_shl:1 row_mask:0xf bank_mask:0xf
    v_mov_b32_dpp v147, v123 row_shl:1 row_mask:0xf bank_mask:0xf
    v_mov_b32_dpp v148, v124 row_shl:1 row_mask:0xf bank_mask:0xf
    v_mov_b32_dpp v149, v125 row_shl:1 row_mask:0xf bank_mask:0xf
    v_mov_b32_dpp v150, v126 row_shl:1 row_mask:0xf bank_mask:0xf
    v_mov_b32_dpp v151, v127 row_shl:1 row_mask:0xf bank_mask:0xf
    v_cndmask_b32 v152, v124, v148, s[18:19]
    v_mov_b32_dpp v153, v124 quad_perm:[0,0,2,2] row_mask:0xf bank_mask:0xf
    v_cndmask_b32 v162, v125, v149, s[18:19]
    v_mov_b32_dpp v163, v125 quad_perm:[0,0,2,2] row_mask:0xf bank_mask:0xf
    v_cndmask_b32 v172, v126, v150, s[18:19]
    v_mov_b32_dpp v173, v126 quad_perm:[0,0,2,2] row_mask:0xf bank_mask:0xf
    v_cndmask_b32 v182, v127, v151, s[18:19]
    v_mov_b32_dpp v183, v127 quad_perm:[0,0,2,2] row_mask:0xf bank_mask:0xf
    v_cndmask_b32 v154, v153, v152, s[22:23]
    v_cvt_pk_bf16_f32 v156, v152, v152
    v_cvt_pk_bf16_f32 v157, v152, v154
    v_mov_b32 v158, v156
    v_cvt_pk_bf16_f32 v159, v154, v153
    ds_write_b64 v13, v[156:157] offset:4544
    ds_write_b64 v13, v[158:159] offset:384
    v_cndmask_b32 v164, v163, v162, s[22:23]
    v_cvt_pk_bf16_f32 v166, v162, v162
    v_cvt_pk_bf16_f32 v167, v162, v164
    v_mov_b32 v168, v166
    v_cvt_pk_bf16_f32 v169, v164, v163
    ds_write_b64 v13, v[166:167] offset:4416
    ds_write_b64 v13, v[168:169] offset:256
    v_cndmask_b32 v174, v173, v172, s[22:23]
    v_cvt_pk_bf16_f32 v176, v172, v172
    v_cvt_pk_bf16_f32 v177, v172, v174
    v_mov_b32 v178, v176
    v_cvt_pk_bf16_f32 v179, v174, v173
    ds_write_b64 v13, v[176:177] offset:4288
    ds_write_b64 v13, v[178:179] offset:128
    v_cndmask_b32 v184, v183, v182, s[22:23]
    v_cvt_pk_bf16_f32 v186, v182, v182
    v_cvt_pk_bf16_f32 v187, v182, v184
    v_mov_b32 v188, v186
    v_cvt_pk_bf16_f32 v189, v184, v183
    ds_write_b64 v13, v[186:187] offset:4160
    ds_write_b64 v13, v[188:189] offset:0
    s_mov_b32 exec_lo, 0
    v_cndmask_b32 v152, v120, v144, s[18:19]
    v_cvt_pk_bf16_f32 v156, v144, v152
    v_cvt_pk_bf16_f32 v157, v120, v120
    v_cvt_pk_bf16_f32 v158, v152, v120
    v_mov_b32 v159, v157
    ds_write_b64 v13, v[156:157] offset:6592
    ds_write_b64 v13, v[158:159] offset:2432
    v_cndmask_b32 v162, v121, v145, s[18:19]
    v_cvt_pk_bf16_f32 v166, v145, v162
    v_cvt_pk_bf16_f32 v167, v121, v121
    v_cvt_pk_bf16_f32 v168, v162, v121
    v_mov_b32 v169, v167
    ds_write_b64 v13, v[166:167] offset:6464
    ds_write_b64 v13, v[168:169] offset:2304
    v_cndmask_b32 v172, v122, v146, s[18:19]
    v_cvt_pk_bf16_f32 v176, v146, v172
    v_cvt_pk_bf16_f32 v177, v122, v122
    v_cvt_pk_bf16_f32 v178, v172, v122
    v_mov_b32 v179, v177
    ds_write_b64 v13, v[176:177] offset:6336
    ds_write_b64 v13, v[178:179] offset:2176
    v_cndmask_b32 v182, v123, v147, s[18:19]
    v_cvt_pk_bf16_f32 v186, v147, v182
    v_cvt_pk_bf16_f32 v187, v123, v123
    v_cvt_pk_bf16_f32 v188, v182, v123
    v_mov_b32 v189, v187
    ds_write_b64 v13, v[186:187] offset:6208
    ds_write_b64 v13, v[188:189] offset:2048
    s_mov_b32 exec_hi, 1
    ds_write_b16 v18, v157 offset:7232
    s_mov_b64 exec, -1
    v_cvt_pk_bf16_f32 v192, v118, v116
    v_cvt_pk_bf16_f32 v193, v116, v116
    ds_write_b32 v12, v192 offset:3072
    ds_write_b32 v12, v193 offset:3076
    v_cvt_pk_bf16_f32 v194, v118, v118
    v_cvt_pk_bf16_f32 v195, v116, v116
    ds_write_b16 v12, v194 offset:7234
    ds_write_b32 v12, v195 offset:7236
    ds_write_b16 v12, v195 offset:7240
    v_cvt_pk_bf16_f32 v196, v115, v115
    v_cvt_pk_bf16_f32 v197, v114, v113
    v_cvt_pk_bf16_f32 v198, v112, v112
    ds_write_b16 v12, v196 offset:3582
    ds_write_b32 v12, v197 offset:3584
    ds_write_b16 v12, v198 offset:3588
    v_cvt_pk_bf16_f32 v199, v115, v114
    v_cvt_pk_bf16_f32 v200, v113, v112
    ds_write_b32 v12, v199 offset:7744
    ds_write_b32 v12, v200 offset:7748
    s_waitcnt vmcnt(0)
    v_mov_b32 v232, 0
    v_mov_b32 v233, 0
    v_dot2_f32_bf16 v232, v216, v208, v232
    v_dot2_f32_bf16 v233, v224, v208, v233
    v_dot2_f32_bf16 v232, v217, v209, v232
    v_dot2_f32_bf16 v233, v225, v209, v233
    v_dot2_f32_bf16 v232, v218, v210, v232
    v_dot2_f32_bf16 v233, v226, v210, v233
    v_dot2_f32_bf16 v232, v219, v211, v232
    v_dot2_f32_bf16 v233, v227, v211, v233
    v_dot2_f32_bf16 v232, v220, v212, v232
    v_dot2_f32_bf16 v233, v228, v212, v233
    v_dot2_f32_bf16 v232, v221, v213, v232
    v_dot2_f32_bf16 v233, v229, v213, v233
    v_dot2_f32_bf16 v232, v222, v214, v232
    v_dot2_f32_bf16 v233, v230, v214, v233
    v_dot2_f32_bf16 v232, v223, v215, v232
    v_dot2_f32_bf16 v233, v231, v215, v233
    s_nop 1
    v_add_f32_dpp v232, v232, v232 row_ror:1 row_mask:0xf bank_mask:0xf
    v_add_f32_dpp v233, v233, v233 row_ror:1 row_mask:0xf bank_mask:0xf
    s_nop 0
    v_add_f32_dpp v232, v232, v232 row_ror:2 row_mask:0xf bank_mask:0xf
    v_add_f32_dpp v233, v233, v233 row_ror:2 row_mask:0xf bank_mask:0xf
    s_nop 0
    v_add_f32_dpp v232, v232, v232 row_ror:4 row_mask:0xf bank_mask:0xf
    v_add_f32_dpp v233, v233, v233 row_ror:4 row_mask:0xf bank_mask:0xf
    s_nop 0
    v_add_f32_dpp v232, v232, v232 row_ror:8 row_mask:0xf bank_mask:0xf
    v_add_f32_dpp v233, v233, v233 row_ror:8 row_mask:0xf bank_mask:0xf
    v_mov_b32 v234, v232
    v_mov_b32 v235, v233
    s_nop 0
    v_permlane16_swap_b32 v232, v234
    v_permlane16_swap_b32 v233, v235
    v_add_f32 v232, v232, v234
    v_add_f32 v233, v233, v235
    v_mul_f32 v232, 0xbfb8aa3b, v232
    v_mul_f32 v233, 0xbfb8aa3b, v233
    v_exp_f32 v232, v232
    v_exp_f32 v233, v233
    v_add_f32 v232, 1.0, v232
    v_add_f32 v233, 1.0, v233
    v_rcp_f32 v232, v232
    v_rcp_f32 v233, v233
    v_lshrrev_b32 v16, 5, v1
    v_lshlrev_b32 v16, 2, v16
    s_lshl_b32 s28, s28, 2
    s_add_u32 s28, s28, 8613888
    s_mov_b32 exec_lo, 1
    s_mov_b32 exec_hi, 1
    buffer_store_dword v232, v16, s[60:63], s28 offen sc1
    buffer_store_dword v233, v16, s[60:63], s28 offen offset:8 sc1
    s_mov_b64 exec, -1
C_EXPD:
    v_and_b32 v2, 15, v1
    v_lshrrev_b32 v3, 4, v1
    v_and_b32 v4, 1, v2
    v_mul_u32_u24 v4, 4160, v4
    v_lshrrev_b32 v5, 1, v2
    v_lshlrev_b32 v6, 2, v3
    v_sub_u32 v5, v6, v5
    v_lshl_add_u32 v4, v5, 2, v4
    s_mul_i32 s7, s14, 8320
    s_lshl_b32 s8, s10, 8
    s_sub_u32 s7, s7, s8
    s_add_u32 s7, s7, 54044
    v_add_u32 v20, s7, v4
    v_subrev_u32 v21, 1024, v20
    v_subrev_u32 v22, 2048, v20
    v_subrev_u32 v23, 3072, v20
    v_lshlrev_b32 v4, 5, v2
    v_lshl_add_u32 v4, v3, 4, v4
    s_mul_i32 s7, s14, 4608
    s_sub_u32 s7, s7, s8
    s_add_u32 s7, s7, 67616
    v_add_u32 v24, s7, v4
    s_waitcnt lgkmcnt(0)
    s_barrier
    s_setprio 0
    ds_read_b128 v[128:131], v24 offset:192
    ds_read2_b32 v[64:65], v20 offset0:176 offset1:177
    ds_read2_b32 v[66:67], v20 offset0:178 offset1:179
    ds_read_b128 v[132:135], v24 offset:704
    ds_read2_b32 v[68:69], v20 offset0:48 offset1:49
    ds_read2_b32 v[70:71], v20 offset0:50 offset1:51
    ds_read_b128 v[136:139], v24 offset:1216
    ds_read2_b32 v[72:73], v21 offset0:176 offset1:177
    ds_read2_b32 v[74:75], v21 offset0:178 offset1:179
    ds_read_b128 v[140:143], v24 offset:1728
    ds_read2_b32 v[76:77], v21 offset0:48 offset1:49
    ds_read2_b32 v[78:79], v21 offset0:50 offset1:51
    ds_read_b128 v[144:147], v24 offset:2240
    ds_read_b128 v[148:151], v24 offset:2752
    ds_read_b128 v[152:155], v24 offset:3264
    ds_read_b128 v[156:159], v24 offset:3776
    s_waitcnt lgkmcnt(0)
    v_mfma_f32_16x16x32_bf16 v[28:31], v[64:67], v[128:131], 0
    ds_read_b128 v[160:163], v24 offset:128
    v_mfma_f32_16x16x32_bf16 v[32:35], v[64:67], v[132:135], 0
    ds_read2_b32 v[96:97], v20 offset0:160 offset1:161
    v_mfma_f32_16x16x32_bf16 v[36:39], v[64:67], v[136:139], 0
    ds_read2_b32 v[98:99], v20 offset0:162 offset1:163
    v_mfma_f32_16x16x32_bf16 v[40:43], v[64:67], v[140:143], 0
    ds_read_b128 v[164:167], v24 offset:640
    v_mfma_f32_16x16x32_bf16 v[44:47], v[64:67], v[144:147], 0
    ds_read2_b32 v[100:101], v20 offset0:32 offset1:33
    v_mfma_f32_16x16x32_bf16 v[48:51], v[64:67], v[148:151], 0
    ds_read2_b32 v[102:103], v20 offset0:34 offset1:35
    v_mfma_f32_16x16x32_bf16 v[52:55], v[64:67], v[152:155], 0
    ds_read_b128 v[168:171], v24 offset:1152
    v_mfma_f32_16x16x32_bf16 v[56:59], v[64:67], v[156:159], 0
    ds_read2_b32 v[104:105], v21 offset0:160 offset1:161
    v_mfma_f32_16x16x32_bf16 v[32:35], v[68:71], v[128:131], v[32:35]
    ds_read2_b32 v[106:107], v21 offset0:162 offset1:163
    v_mfma_f32_16x16x32_bf16 v[36:39], v[68:71], v[132:135], v[36:39]
    ds_read_b128 v[172:175], v24 offset:1664
    v_mfma_f32_16x16x32_bf16 v[40:43], v[68:71], v[136:139], v[40:43]
    ds_read2_b32 v[108:109], v21 offset0:32 offset1:33
    v_mfma_f32_16x16x32_bf16 v[44:47], v[68:71], v[140:143], v[44:47]
    ds_read2_b32 v[110:111], v21 offset0:34 offset1:35
    v_mfma_f32_16x16x32_bf16 v[48:51], v[68:71], v[144:147], v[48:51]
    v_mfma_f32_16x16x32_bf16 v[52:55], v[68:71], v[148:151], v[52:55]
    v_mfma_f32_16x16x32_bf16 v[56:59], v[68:71], v[152:155], v[56:59]
    v_mfma_f32_16x16x32_bf16 v[36:39], v[72:75], v[128:131], v[36:39]
    v_mfma_f32_16x16x32_bf16 v[40:43], v[72:75], v[132:135], v[40:43]
    v_mfma_f32_16x16x32_bf16 v[44:47], v[72:75], v[136:139], v[44:47]
    v_mfma_f32_16x16x32_bf16 v[48:51], v[72:75], v[140:143], v[48:51]
    v_mfma_f32_16x16x32_bf16 v[52:55], v[72:75], v[144:147], v[52:55]
    v_mfma_f32_16x16x32_bf16 v[56:59], v[72:75], v[148:151], v[56:59]
    v_mfma_f32_16x16x32_bf16 v[40:43], v[76:79], v[128:131], v[40:43]
    v_mfma_f32_16x16x32_bf16 v[44:47], v[76:79], v[132:135], v[44:47]
    v_mfma_f32_16x16x32_bf16 v[48:51], v[76:79], v[136:139], v[48:51]
    ds_read2_b32 v[80:81], v22 offset0:176 offset1:177
    ds_read2_b32 v[82:83], v22 offset0:178 offset1:179
    ds_read2_b32 v[84:85], v22 offset0:48 offset1:49
    ds_read2_b32 v[86:87], v22 offset0:50 offset1:51
    ds_read2_b32 v[88:89], v23 offset0:176 offset1:177
    ds_read2_b32 v[90:91], v23 offset0:178 offset1:179
    ds_read2_b32 v[92:93], v23 offset0:48 offset1:49
    ds_read2_b32 v[94:95], v23 offset0:50 offset1:51
    v_mfma_f32_16x16x32_bf16 v[52:55], v[76:79], v[140:143], v[52:55]
    v_mfma_f32_16x16x32_bf16 v[56:59], v[76:79], v[144:147], v[56:59]
    s_waitcnt lgkmcnt(0)
    v_mfma_f32_16x16x32_bf16 v[44:47], v[80:83], v[128:131], v[44:47]
    v_mfma_f32_16x16x32_bf16 v[48:51], v[80:83], v[132:135], v[48:51]
    v_mfma_f32_16x16x32_bf16 v[52:55], v[80:83], v[136:139], v[52:55]
    v_mfma_f32_16x16x32_bf16 v[56:59], v[80:83], v[140:143], v[56:59]
    v_mfma_f32_16x16x32_bf16 v[48:51], v[84:87], v[128:131], v[48:51]
    v_mfma_f32_16x16x32_bf16 v[52:55], v[84:87], v[132:135], v[52:55]
    v_mfma_f32_16x16x32_bf16 v[56:59], v[84:87], v[136:139], v[56:59]
    v_mfma_f32_16x16x32_bf16 v[52:55], v[88:91], v[128:131], v[52:55]
    ds_read_b128 v[176:179], v24 offset:2176
    ds_read_b128 v[180:183], v24 offset:2688
    ds_read_b128 v[184:187], v24 offset:3200
    ds_read_b128 v[188:191], v24 offset:3712
    v_mfma_f32_16x16x32_bf16 v[56:59], v[88:91], v[132:135], v[56:59]
    v_mfma_f32_16x16x32_bf16 v[56:59], v[92:95], v[128:131], v[56:59]
    s_waitcnt lgkmcnt(0)
    v_mfma_f32_16x16x32_bf16 v[28:31], v[96:99], v[160:163], v[28:31]
    ds_read_b128 v[128:131], v24 offset:64
    v_mfma_f32_16x16x32_bf16 v[32:35], v[96:99], v[164:167], v[32:35]
    ds_read2_b32 v[64:65], v20 offset0:144 offset1:145
    v_mfma_f32_16x16x32_bf16 v[36:39], v[96:99], v[168:171], v[36:39]
    ds_read2_b32 v[66:67], v20 offset0:146 offset1:147
    v_mfma_f32_16x16x32_bf16 v[40:43], v[96:99], v[172:175], v[40:43]
    ds_read_b128 v[132:135], v24 offset:576
    v_mfma_f32_16x16x32_bf16 v[44:47], v[96:99], v[176:179], v[44:47]
    ds_read2_b32 v[68:69], v20 offset0:16 offset1:17
    v_mfma_f32_16x16x32_bf16 v[48:51], v[96:99], v[180:183], v[48:51]
    ds_read2_b32 v[70:71], v20 offset0:18 offset1:19
    v_mfma_f32_16x16x32_bf16 v[52:55], v[96:99], v[184:187], v[52:55]
    ds_read_b128 v[136:139], v24 offset:1088
    v_mfma_f32_16x16x32_bf16 v[56:59], v[96:99], v[188:191], v[56:59]
    ds_read2_b32 v[72:73], v21 offset0:144 offset1:145
    v_mfma_f32_16x16x32_bf16 v[32:35], v[100:103], v[160:163], v[32:35]
    ds_read2_b32 v[74:75], v21 offset0:146 offset1:147
    v_mfma_f32_16x16x32_bf16 v[36:39], v[100:103], v[164:167], v[36:39]
    ds_read_b128 v[140:143], v24 offset:1600
    v_mfma_f32_16x16x32_bf16 v[40:43], v[100:103], v[168:171], v[40:43]
    ds_read2_b32 v[76:77], v21 offset0:16 offset1:17
    v_mfma_f32_16x16x32_bf16 v[44:47], v[100:103], v[172:175], v[44:47]
    ds_read2_b32 v[78:79], v21 offset0:18 offset1:19
    v_mfma_f32_16x16x32_bf16 v[48:51], v[100:103], v[176:179], v[48:51]
    v_mfma_f32_16x16x32_bf16 v[52:55], v[100:103], v[180:183], v[52:55]
    v_mfma_f32_16x16x32_bf16 v[56:59], v[100:103], v[184:187], v[56:59]
    v_mfma_f32_16x16x32_bf16 v[36:39], v[104:107], v[160:163], v[36:39]
    v_mfma_f32_16x16x32_bf16 v[40:43], v[104:107], v[164:167], v[40:43]
    v_mfma_f32_16x16x32_bf16 v[44:47], v[104:107], v[168:171], v[44:47]
    v_mfma_f32_16x16x32_bf16 v[48:51], v[104:107], v[172:175], v[48:51]
    v_mfma_f32_16x16x32_bf16 v[52:55], v[104:107], v[176:179], v[52:55]
    v_mfma_f32_16x16x32_bf16 v[56:59], v[104:107], v[180:183], v[56:59]
    v_mfma_f32_16x16x32_bf16 v[40:43], v[108:111], v[160:163], v[40:43]
    v_mfma_f32_16x16x32_bf16 v[44:47], v[108:111], v[164:167], v[44:47]
    v_mfma_f32_16x16x32_bf16 v[48:51], v[108:111], v[168:171], v[48:51]
    ds_read2_b32 v[112:113], v22 offset0:160 offset1:161
    ds_read2_b32 v[114:115], v22 offset0:162 offset1:163
    ds_read2_b32 v[116:117], v22 offset0:32 offset1:33
    ds_read2_b32 v[118:119], v22 offset0:34 offset1:35
    ds_read2_b32 v[120:121], v23 offset0:160 offset1:161
    ds_read2_b32 v[122:123], v23 offset0:162 offset1:163
    ds_read2_b32 v[124:125], v23 offset0:32 offset1:33
    ds_read2_b32 v[126:127], v23 offset0:34 offset1:35
    v_mfma_f32_16x16x32_bf16 v[52:55], v[108:111], v[172:175], v[52:55]
    v_mfma_f32_16x16x32_bf16 v[56:59], v[108:111], v[176:179], v[56:59]
    s_waitcnt lgkmcnt(0)
    v_mfma_f32_16x16x32_bf16 v[44:47], v[112:115], v[160:163], v[44:47]
    v_mfma_f32_16x16x32_bf16 v[48:51], v[112:115], v[164:167], v[48:51]
    v_mfma_f32_16x16x32_bf16 v[52:55], v[112:115], v[168:171], v[52:55]
    v_mfma_f32_16x16x32_bf16 v[56:59], v[112:115], v[172:175], v[56:59]
    v_mfma_f32_16x16x32_bf16 v[48:51], v[116:119], v[160:163], v[48:51]
    v_mfma_f32_16x16x32_bf16 v[52:55], v[116:119], v[164:167], v[52:55]
    v_mfma_f32_16x16x32_bf16 v[56:59], v[116:119], v[168:171], v[56:59]
    v_mfma_f32_16x16x32_bf16 v[52:55], v[120:123], v[160:163], v[52:55]
    ds_read_b128 v[144:147], v24 offset:2112
    ds_read_b128 v[148:151], v24 offset:2624
    ds_read_b128 v[152:155], v24 offset:3136
    ds_read_b128 v[156:159], v24 offset:3648
    v_mfma_f32_16x16x32_bf16 v[56:59], v[120:123], v[164:167], v[56:59]
    v_mfma_f32_16x16x32_bf16 v[56:59], v[124:127], v[160:163], v[56:59]
    s_waitcnt lgkmcnt(0)
    v_mfma_f32_16x16x32_bf16 v[28:31], v[64:67], v[128:131], v[28:31]
    ds_read_b128 v[160:163], v24 offset:0
    v_mfma_f32_16x16x32_bf16 v[32:35], v[64:67], v[132:135], v[32:35]
    ds_read2_b32 v[96:97], v20 offset0:128 offset1:129
    v_mfma_f32_16x16x32_bf16 v[36:39], v[64:67], v[136:139], v[36:39]
    ds_read2_b32 v[98:99], v20 offset0:130 offset1:131
    v_mfma_f32_16x16x32_bf16 v[40:43], v[64:67], v[140:143], v[40:43]
    ds_read_b128 v[164:167], v24 offset:512
    v_mfma_f32_16x16x32_bf16 v[44:47], v[64:67], v[144:147], v[44:47]
    ds_read2_b32 v[100:101], v20 offset0:0 offset1:1
    v_mfma_f32_16x16x32_bf16 v[48:51], v[64:67], v[148:151], v[48:51]
    ds_read2_b32 v[102:103], v20 offset0:2 offset1:3
    v_mfma_f32_16x16x32_bf16 v[52:55], v[64:67], v[152:155], v[52:55]
    ds_read_b128 v[168:171], v24 offset:1024
    v_mfma_f32_16x16x32_bf16 v[56:59], v[64:67], v[156:159], v[56:59]
    ds_read2_b32 v[104:105], v21 offset0:128 offset1:129
    v_mfma_f32_16x16x32_bf16 v[32:35], v[68:71], v[128:131], v[32:35]
    ds_read2_b32 v[106:107], v21 offset0:130 offset1:131
    v_mfma_f32_16x16x32_bf16 v[36:39], v[68:71], v[132:135], v[36:39]
    ds_read_b128 v[172:175], v24 offset:1536
    v_mfma_f32_16x16x32_bf16 v[40:43], v[68:71], v[136:139], v[40:43]
    ds_read2_b32 v[108:109], v21 offset0:0 offset1:1
    v_mfma_f32_16x16x32_bf16 v[44:47], v[68:71], v[140:143], v[44:47]
    ds_read2_b32 v[110:111], v21 offset0:2 offset1:3
    v_mfma_f32_16x16x32_bf16 v[48:51], v[68:71], v[144:147], v[48:51]
    v_mfma_f32_16x16x32_bf16 v[52:55], v[68:71], v[148:151], v[52:55]
    v_mfma_f32_16x16x32_bf16 v[56:59], v[68:71], v[152:155], v[56:59]
    v_mfma_f32_16x16x32_bf16 v[36:39], v[72:75], v[128:131], v[36:39]
    v_mfma_f32_16x16x32_bf16 v[40:43], v[72:75], v[132:135], v[40:43]
    v_mfma_f32_16x16x32_bf16 v[44:47], v[72:75], v[136:139], v[44:47]
    v_mfma_f32_16x16x32_bf16 v[48:51], v[72:75], v[140:143], v[48:51]
    v_mfma_f32_16x16x32_bf16 v[52:55], v[72:75], v[144:147], v[52:55]
    v_mfma_f32_16x16x32_bf16 v[56:59], v[72:75], v[148:151], v[56:59]
    v_mfma_f32_16x16x32_bf16 v[40:43], v[76:79], v[128:131], v[40:43]
    v_mfma_f32_16x16x32_bf16 v[44:47], v[76:79], v[132:135], v[44:47]
    v_mfma_f32_16x16x32_bf16 v[48:51], v[76:79], v[136:139], v[48:51]
    ds_read2_b32 v[80:81], v22 offset0:144 offset1:145
    ds_read2_b32 v[82:83], v22 offset0:146 offset1:147
    ds_read2_b32 v[84:85], v22 offset0:16 offset1:17
    ds_read2_b32 v[86:87], v22 offset0:18 offset1:19
    ds_read2_b32 v[88:89], v23 offset0:144 offset1:145
    ds_read2_b32 v[90:91], v23 offset0:146 offset1:147
    ds_read2_b32 v[92:93], v23 offset0:16 offset1:17
    ds_read2_b32 v[94:95], v23 offset0:18 offset1:19
    v_mfma_f32_16x16x32_bf16 v[52:55], v[76:79], v[140:143], v[52:55]
    v_mfma_f32_16x16x32_bf16 v[56:59], v[76:79], v[144:147], v[56:59]
    s_waitcnt lgkmcnt(0)
    v_mfma_f32_16x16x32_bf16 v[44:47], v[80:83], v[128:131], v[44:47]
    v_mfma_f32_16x16x32_bf16 v[48:51], v[80:83], v[132:135], v[48:51]
    v_mfma_f32_16x16x32_bf16 v[52:55], v[80:83], v[136:139], v[52:55]
    v_mfma_f32_16x16x32_bf16 v[56:59], v[80:83], v[140:143], v[56:59]
    v_mfma_f32_16x16x32_bf16 v[48:51], v[84:87], v[128:131], v[48:51]
    v_mfma_f32_16x16x32_bf16 v[52:55], v[84:87], v[132:135], v[52:55]
    v_mfma_f32_16x16x32_bf16 v[56:59], v[84:87], v[136:139], v[56:59]
    v_mfma_f32_16x16x32_bf16 v[52:55], v[88:91], v[128:131], v[52:55]
    ds_read_b128 v[176:179], v24 offset:2048
    ds_read_b128 v[180:183], v24 offset:2560
    ds_read_b128 v[184:187], v24 offset:3072
    ds_read_b128 v[188:191], v24 offset:3584
    v_mfma_f32_16x16x32_bf16 v[56:59], v[88:91], v[132:135], v[56:59]
    v_mfma_f32_16x16x32_bf16 v[56:59], v[92:95], v[128:131], v[56:59]
    s_waitcnt lgkmcnt(0)
    v_mfma_f32_16x16x32_bf16 v[28:31], v[96:99], v[160:163], v[28:31]
    v_mfma_f32_16x16x32_bf16 v[32:35], v[96:99], v[164:167], v[32:35]
    v_mfma_f32_16x16x32_bf16 v[36:39], v[96:99], v[168:171], v[36:39]
    v_mfma_f32_16x16x32_bf16 v[40:43], v[96:99], v[172:175], v[40:43]
    v_mfma_f32_16x16x32_bf16 v[44:47], v[96:99], v[176:179], v[44:47]
    v_mfma_f32_16x16x32_bf16 v[48:51], v[96:99], v[180:183], v[48:51]
    v_mfma_f32_16x16x32_bf16 v[52:55], v[96:99], v[184:187], v[52:55]
    v_mfma_f32_16x16x32_bf16 v[56:59], v[96:99], v[188:191], v[56:59]
    v_mfma_f32_16x16x32_bf16 v[32:35], v[100:103], v[160:163], v[32:35]
    v_mfma_f32_16x16x32_bf16 v[36:39], v[100:103], v[164:167], v[36:39]
    v_mfma_f32_16x16x32_bf16 v[40:43], v[100:103], v[168:171], v[40:43]
    v_mfma_f32_16x16x32_bf16 v[44:47], v[100:103], v[172:175], v[44:47]
    v_mfma_f32_16x16x32_bf16 v[48:51], v[100:103], v[176:179], v[48:51]
    v_mfma_f32_16x16x32_bf16 v[52:55], v[100:103], v[180:183], v[52:55]
    v_mfma_f32_16x16x32_bf16 v[56:59], v[100:103], v[184:187], v[56:59]
    v_mfma_f32_16x16x32_bf16 v[36:39], v[104:107], v[160:163], v[36:39]
    v_mfma_f32_16x16x32_bf16 v[40:43], v[104:107], v[164:167], v[40:43]
    v_mfma_f32_16x16x32_bf16 v[44:47], v[104:107], v[168:171], v[44:47]
    v_mfma_f32_16x16x32_bf16 v[48:51], v[104:107], v[172:175], v[48:51]
    v_mfma_f32_16x16x32_bf16 v[52:55], v[104:107], v[176:179], v[52:55]
    v_mfma_f32_16x16x32_bf16 v[56:59], v[104:107], v[180:183], v[56:59]
    v_mfma_f32_16x16x32_bf16 v[40:43], v[108:111], v[160:163], v[40:43]
    v_mfma_f32_16x16x32_bf16 v[44:47], v[108:111], v[164:167], v[44:47]
    v_mfma_f32_16x16x32_bf16 v[48:51], v[108:111], v[168:171], v[48:51]
    ds_read2_b32 v[112:113], v22 offset0:128 offset1:129
    ds_read2_b32 v[114:115], v22 offset0:130 offset1:131
    ds_read2_b32 v[116:117], v22 offset0:0 offset1:1
    ds_read2_b32 v[118:119], v22 offset0:2 offset1:3
    ds_read2_b32 v[120:121], v23 offset0:128 offset1:129
    ds_read2_b32 v[122:123], v23 offset0:130 offset1:131
    ds_read2_b32 v[124:125], v23 offset0:0 offset1:1
    ds_read2_b32 v[126:127], v23 offset0:2 offset1:3
    v_mfma_f32_16x16x32_bf16 v[52:55], v[108:111], v[172:175], v[52:55]
    v_mfma_f32_16x16x32_bf16 v[56:59], v[108:111], v[176:179], v[56:59]
    s_waitcnt lgkmcnt(0)
    v_mfma_f32_16x16x32_bf16 v[44:47], v[112:115], v[160:163], v[44:47]
    v_mfma_f32_16x16x32_bf16 v[48:51], v[112:115], v[164:167], v[48:51]
    v_mfma_f32_16x16x32_bf16 v[52:55], v[112:115], v[168:171], v[52:55]
    v_mfma_f32_16x16x32_bf16 v[56:59], v[112:115], v[172:175], v[56:59]
    v_mfma_f32_16x16x32_bf16 v[48:51], v[116:119], v[160:163], v[48:51]
    v_mfma_f32_16x16x32_bf16 v[52:55], v[116:119], v[164:167], v[52:55]
    v_mfma_f32_16x16x32_bf16 v[56:59], v[116:119], v[168:171], v[56:59]
    v_mfma_f32_16x16x32_bf16 v[52:55], v[120:123], v[160:163], v[52:55]
    v_mfma_f32_16x16x32_bf16 v[56:59], v[120:123], v[164:167], v[56:59]
    v_mfma_f32_16x16x32_bf16 v[56:59], v[124:127], v[160:163], v[56:59]
    s_setprio 3
    s_cmp_eq_u32 s6, 1
    s_cbranch_scc0 C_NZ1
    s_lshl_b32 s13, s4, 2
    buffer_load_dword v241, v243, s[64:67], s13 offen offset:128 sc1
C_NZ1:
    s_mul_i32 s7, s6, 12672
    v_lshlrev_b32 v4, 4, v1
    v_add_u32 v5, s7, v4
    s_xor_b32 s8, s6, 1
    s_mul_i32 s8, s8, 12672
    v_add_u32 v6, s8, v4
    s_lshl_b32 s7, s9, 12
    s_lshl_b32 s8, s10, 11
    s_add_u32 s7, s7, s8
    s_add_u32 s7, s7, 2097152
    v_lshlrev_b32 v7, 5, v2
    v_lshl_add_u32 v7, v3, 3, v7
    s_cmp_eq_u32 s10, 0
    s_cbranch_scc1 C_H0
    ds_write_b128 v5, v[28:31] offset:0
    ds_write_b128 v5, v[32:35] offset:1024
    ds_write_b128 v5, v[36:39] offset:2048
    ds_write_b128 v5, v[40:43] offset:3072
    v_mov_b32 v28, v44
    v_mov_b32 v29, v45
    v_mov_b32 v30, v46
    v_mov_b32 v31, v47
    v_mov_b32 v32, v48
    v_mov_b32 v33, v49
    v_mov_b32 v34, v50
    v_mov_b32 v35, v51
    v_mov_b32 v36, v52
    v_mov_b32 v37, v53
    v_mov_b32 v38, v54
    v_mov_b32 v39, v55
    v_mov_b32 v40, v56
    v_mov_b32 v41, v57
    v_mov_b32 v42, v58
    v_mov_b32 v43, v59
    s_branch C_HJ
C_H0:
    ds_write_b128 v5, v[44:47] offset:0
    ds_write_b128 v5, v[48:51] offset:1024
    ds_write_b128 v5, v[52:55] offset:2048
    ds_write_b128 v5, v[56:59] offset:3072
C_HJ:
    s_waitcnt lgkmcnt(0)
    s_barrier
    ds_read_b128 v[64:67], v6 offset:0
    ds_read_b128 v[68:71], v6 offset:1024
    ds_read_b128 v[72:75], v6 offset:2048
    ds_read_b128 v[76:79], v6 offset:3072
    s_waitcnt lgkmcnt(3)
    v_pk_add_f32 v[28:29], v[28:29], v[64:65]
    v_pk_add_f32 v[30:31], v[30:31], v[66:67]
    v_cvt_pk_bf16_f32 v128, v28, v29
    v_cvt_pk_bf16_f32 v129, v30, v31
    buffer_store_dwordx2 v[128:129], v7, s[60:63], s7 offen offset:0 sc1
    s_waitcnt lgkmcnt(2)
    v_pk_add_f32 v[32:33], v[32:33], v[68:69]
    v_pk_add_f32 v[34:35], v[34:35], v[70:71]
    v_cvt_pk_bf16_f32 v130, v32, v33
    v_cvt_pk_bf16_f32 v131, v34, v35
    buffer_store_dwordx2 v[130:131], v7, s[60:63], s7 offen offset:512 sc1
    s_waitcnt lgkmcnt(1)
    v_pk_add_f32 v[36:37], v[36:37], v[72:73]
    v_pk_add_f32 v[38:39], v[38:39], v[74:75]
    v_cvt_pk_bf16_f32 v132, v36, v37
    v_cvt_pk_bf16_f32 v133, v38, v39
    buffer_store_dwordx2 v[132:133], v7, s[60:63], s7 offen offset:1024 sc1
    s_waitcnt lgkmcnt(0)
    v_pk_add_f32 v[40:41], v[40:41], v[76:77]
    v_pk_add_f32 v[42:43], v[42:43], v[78:79]
    v_cvt_pk_bf16_f32 v134, v40, v41
    v_cvt_pk_bf16_f32 v135, v42, v43
    buffer_store_dwordx2 v[134:135], v7, s[60:63], s7 offen offset:1536 sc1
    s_waitcnt vmcnt(0)
    s_barrier
    s_cmp_eq_u32 s6, 1
    s_cbranch_scc0 C_END
    s_mov_b32 s8, 0
C_ZP:
    v_readfirstlane_b32 s7, v241
    s_nop 1
    s_cmp_lg_u32 s7, 0
    s_cbranch_scc1 C_ZOK
    s_add_u32 s8, s8, 1
    s_cmp_gt_u32 s8, 100000
    s_cbranch_scc1 C_ZOK
    s_sleep 16
    buffer_load_dword v241, v243, s[64:67], s13 offen offset:128 sc1
    s_waitcnt vmcnt(0)
    s_branch C_ZP
C_ZOK:
    s_add_u32 s8, s4, 8
    v_lshlrev_b32 v8, 12, v1
    s_lshl_b32 s7, s8, 8
    s_add_u32 s7, s7, 8568832
    v_mov_b32 v9, 1
    s_mov_b64 exec, 0xff
    buffer_atomic_add v9, v8, s[60:63], s7 offen sc1
    s_mov_b64 exec, -1
C_END:
    s_endpgm
K_GEMM:
    s_and_b32 s3, s2, 7
    s_bfe_u32 s4, s2, 0x50003
    s_and_b32 s11, s4, 3
    s_lshr_b32 s7, s3, 1
    s_lshl_b32 s7, s7, 2
    s_add_u32 s7, s7, s11
    s_lshr_b32 s8, s4, 3
    s_lshl_b32 s8, s8, 1
    s_and_b32 s11, s3, 1
    s_add_u32 s8, s8, s11
    s_lshl_b32 s8, s8, 1
    s_bfe_u32 s11, s4, 0x10002
    s_add_u32 s8, s8, s11
    v_lshrrev_b32 v120, 6, v0
    v_and_b32 v1, 63, v0
    v_readfirstlane_b32 s10, v120
    v_lshrrev_b32 v116, 3, v1
    v_and_b32 v117, 7, v1
    v_lshrrev_b32 v118, 1, v116
    v_xor_b32 v119, v117, v118
    v_lshlrev_b32 v119, 4, v119
    v_lshl_add_u32 v2, v116, 10, v119
    v_lshrrev_b32 v116, 2, v1
    v_and_b32 v119, 3, v1
    v_lshlrev_b32 v119, 4, v119
    v_mul_u32_u24 v4, 3072, v116
    v_add_u32 v4, v4, v119
    s_lshl_b32 s11, s7, 17
    s_lshl_b32 s12, s10, 15
    s_add_u32 s11, s11, s12
    v_add_u32 v2, s11, v2
    v_xor_b32 v3, 64, v2
    s_mul_i32 s11, s10, 49152
    s_lshl_b32 s12, s8, 6
    s_add_u32 s11, s11, s12
    v_add_u32 v4, s11, v4
    s_lshl_b32 s14, s10, 12
    s_lshl_b32 s15, s10, 10
    s_lshr_b32 s9, s4, 2
    s_and_b32 s11, s4, 3
    s_lshl_b32 s11, s11, 1
    s_add_u32 s9, s9, s11
    s_and_b32 s50, s9, 7
    s_and_b32 s9, s9, 6
    s_mul_i32 s11, s3, 0
    s_add_u32 s9, s9, s11
    v_and_b32 v126, 7, v1
    v_lshlrev_b32 v125, 7, v126
    v_lshlrev_b32 v126, 2, v126
    s_lshl_b32 s6, s8, 11
    v_lshrrev_b32 v120, 2, v1
    v_lshlrev_b32 v120, 10, v120
    v_and_b32 v121, 3, v1
    v_lshl_add_u32 v120, v121, 4, v120
    s_lshl_b32 s11, s7, 17
    s_lshl_b32 s12, s10, 15
    s_add_u32 s11, s11, s12
    s_lshl_b32 s12, s8, 6
    s_add_u32 s11, s11, s12
    v_add_u32 v120, s11, v120
    s_lshl_b32 s11, s10, 11
    s_add_u32 m0, s11, 73728
    s_and_b32 s11, s10, 1
    s_lshl_b32 s11, s11, 10
    s_add_u32 s6, s6, s11
    s_lshl_b32 s11, s7, 2
    s_add_u32 s6, s6, s11
    s_add_u32 s6, s6, 8519680
    s_waitcnt lgkmcnt(0)
    s_setprio 2
    s_mov_b32 s52, s16
    s_mov_b32 s53, s17
    s_mov_b32 s54, 0x200000
    s_mov_b32 s55, 0x20000
    s_mov_b32 s56, s18
    s_mov_b32 s57, s19
    s_mov_b32 s58, 0x180000
    s_mov_b32 s59, 0x20000
    s_mov_b32 s60, s48
    s_mov_b32 s61, s49
    s_mov_b32 s62, 0x900000
    s_mov_b32 s63, 0x20000
    s_mov_b32 s11, 15360
    buffer_load_dwordx4 v120, s[52:55], 0 offen lds
    buffer_load_dwordx4 v120, s[52:55], s11 offen offset:1024 lds
    s_add_u32 s13, s9, 0
    s_and_b32 s13, s13, 7
    s_lshl_b32 s11, s13, 7
    s_add_u32 m0, s14, 0
    s_add_u32 s12, s11, 7168
    buffer_load_dwordx4 v2, s[52:55], s11 offen lds
    buffer_load_dwordx4 v3, s[52:55], s12 offen offset:1024 lds
    s_add_u32 s12, s11, 21504
    s_add_u32 s11, s11, 14336
    s_mul_i32 s13, s13, 196608
    buffer_load_dwordx4 v2, s[52:55], s11 offen offset:2048 lds
    buffer_load_dwordx4 v3, s[52:55], s12 offen offset:3072 lds
    s_add_u32 m0, s15, 16384
    s_add_u32 s11, s13, 1024
    s_add_u32 s12, s13, 2048
    buffer_load_dwordx4 v4, s[56:59], s11 offen lds
    s_add_u32 m0, s15, 20480
    s_nop 0
    buffer_load_dwordx4 v4, s[56:59], s12 offen lds
    s_mov_b64 exec, 0xff
    buffer_load_dword v0, v125, s[60:63], s6 offen sc1
    s_mov_b64 exec, -1
    s_add_u32 s13, s9, 1
    s_and_b32 s13, s13, 7
    s_lshl_b32 s11, s13, 7
    s_add_u32 m0, s14, 24576
    s_add_u32 s12, s11, 7168
    buffer_load_dwordx4 v2, s[52:55], s11 offen lds
    buffer_load_dwordx4 v3, s[52:55], s12 offen offset:1024 lds
    s_add_u32 s12, s11, 21504
    s_add_u32 s11, s11, 14336
    s_mul_i32 s13, s13, 196608
    buffer_load_dwordx4 v2, s[52:55], s11 offen offset:2048 lds
    buffer_load_dwordx4 v3, s[52:55], s12 offen offset:3072 lds
    s_add_u32 m0, s15, 40960
    s_add_u32 s11, s13, 1024
    s_add_u32 s12, s13, 2048
    buffer_load_dwordx4 v4, s[56:59], s11 offen lds
    s_add_u32 m0, s15, 45056
    s_nop 0
    buffer_load_dwordx4 v4, s[56:59], s12 offen lds
    v_and_b32 v116, 31, v1
    v_lshrrev_b32 v117, 3, v116
    v_lshlrev_b32 v117, 2, v117
    v_and_b32 v118, 3, v116
    v_add_u32 v117, v117, v118
    v_lshlrev_b32 v117, 1, v117
    v_lshrrev_b32 v118, 5, v1
    v_lshl_add_u32 v117, v118, 7, v117
    s_lshl_b32 s12, s8, 10
    v_add_u32 v117, s12, v117
    s_mov_b32 s64, s46
    s_mov_b32 s65, s47
    s_mov_b32 s66, 0x100
    s_mov_b32 s67, 0x20000
    global_load_ushort v240, v117, s[20:21] offset:0
    global_load_ushort v241, v117, s[20:21] offset:32
    global_load_ushort v242, v117, s[20:21] offset:64
    global_load_ushort v243, v117, s[20:21] offset:96
    global_load_ushort v244, v117, s[20:21] offset:256
    global_load_ushort v245, v117, s[20:21] offset:288
    global_load_ushort v246, v117, s[20:21] offset:320
    global_load_ushort v247, v117, s[20:21] offset:352
    global_load_ushort v248, v117, s[20:21] offset:512
    global_load_ushort v249, v117, s[20:21] offset:544
    global_load_ushort v250, v117, s[20:21] offset:576
    global_load_ushort v251, v117, s[20:21] offset:608
    global_load_ushort v252, v117, s[20:21] offset:768
    global_load_ushort v253, v117, s[20:21] offset:800
    global_load_ushort v254, v117, s[20:21] offset:832
    global_load_ushort v255, v117, s[20:21] offset:864
    s_add_u32 s13, s9, 2
    s_and_b32 s13, s13, 7
    s_lshl_b32 s11, s13, 7
    s_add_u32 m0, s14, 49152
    s_add_u32 s12, s11, 7168
    buffer_load_dwordx4 v2, s[52:55], s11 offen lds
    buffer_load_dwordx4 v3, s[52:55], s12 offen offset:1024 lds
    s_add_u32 s12, s11, 21504
    s_add_u32 s11, s11, 14336
    s_mul_i32 s13, s13, 196608
    buffer_load_dwordx4 v2, s[52:55], s11 offen offset:2048 lds
    buffer_load_dwordx4 v3, s[52:55], s12 offen offset:3072 lds
    s_add_u32 m0, s15, 65536
    s_add_u32 s11, s13, 1024
    s_add_u32 s12, s13, 2048
    buffer_load_dwordx4 v4, s[56:59], s11 offen lds
    s_add_u32 m0, s15, 69632
    s_nop 0
    buffer_load_dwordx4 v4, s[56:59], s12 offen lds
    s_and_b32 s30, s8, 3
    s_lshl_b32 s11, s7, 2
    s_add_u32 s30, s30, s11
    s_lshr_b32 s31, s8, 2
    s_lshl_b32 s25, s3, 12
    s_add_u32 s25, s25, 8570880
    v_and_b32 v120, 31, v1
    s_lshl_b32 s11, s10, 5
    v_add_u32 v120, s11, v120
    v_bfe_u32 v121, v120, 1, 3
    v_xor_b32 v121, v121, v118
    v_lshlrev_b32 v121, 4, v121
    v_lshl_add_u32 v5, v120, 7, v121
    v_xor_b32 v6, 32, v5
    v_xor_b32 v7, 64, v5
    v_xor_b32 v8, 96, v5
    v_bfe_u32 v120, v1, 2, 2
    v_lshl_add_u32 v121, v118, 3, v120
    v_lshlrev_b32 v121, 6, v121
    v_bfe_u32 v120, v1, 4, 1
    v_lshl_add_u32 v121, v120, 5, v121
    v_and_b32 v120, 3, v1
    v_lshl_add_u32 v9, v120, 3, v121
    v_add_u32 v10, 0x8000, v9
    v_lshrrev_b32 v224, 4, v1
    v_bfe_u32 v225, v1, 2, 2
    v_lshl_add_u32 v225, v224, 3, v225
    v_lshlrev_b32 v116, 6, v225
    v_and_b32 v226, 3, v1
    v_lshl_add_u32 v116, v226, 3, v116
    s_and_b32 s12, s10, 1
    s_lshl_b32 s11, s12, 5
    s_add_u32 s11, s11, 73728
    v_add_u32 v116, s11, v116
    v_and_b32 v118, 15, v1
    s_lshl_b32 s11, s8, 1
    s_add_u32 s11, s11, s12
    s_lshl_b32 s11, s11, 4
    v_add_u32 v118, s11, v118
    v_lshlrev_b32 v118, 12, v118
    v_lshl_add_u32 v118, v224, 4, v118
    s_lshl_b32 s51, s7, 8
    s_waitcnt vmcnt(35)
    s_barrier
    s_cmp_lt_u32 s10, 2
    s_cbranch_scc0 G_NTR
    ds_read_b64_tr_b16 v[224:225], v116 offset:0
    ds_read_b64_tr_b16 v[226:227], v116 offset:256
    ds_read_b64_tr_b16 v[228:229], v116 offset:2048
    ds_read_b64_tr_b16 v[230:231], v116 offset:2304
    ds_read_b64_tr_b16 v[232:233], v116 offset:4096
    ds_read_b64_tr_b16 v[234:235], v116 offset:4352
    ds_read_b64_tr_b16 v[236:237], v116 offset:6144
    ds_read_b64_tr_b16 v[238:239], v116 offset:6400
    s_waitcnt lgkmcnt(6)
    buffer_store_dwordx4 v[224:227], v118, s[60:63], s51 offen offset:0 sc1
    s_waitcnt lgkmcnt(4)
    buffer_store_dwordx4 v[228:231], v118, s[60:63], s51 offen offset:64 sc1
    s_waitcnt lgkmcnt(2)
    buffer_store_dwordx4 v[232:235], v118, s[60:63], s51 offen offset:128 sc1
    s_waitcnt lgkmcnt(0)
    buffer_store_dwordx4 v[236:239], v118, s[60:63], s51 offen offset:192 sc1
G_NTR:
    s_cmp_lt_u32 s10, 2
    s_cbranch_scc1 G_WS0
    s_waitcnt vmcnt(29)
G_WS0:
    s_waitcnt vmcnt(33)
    s_barrier
    ds_read_b128 v[128:131], v5 offset:0
    ds_read_b64_tr_b16 v[52:53], v9 offset:16384
    ds_read_b64_tr_b16 v[54:55], v9 offset:16640
    ds_read_b64_tr_b16 v[56:57], v9 offset:20480
    ds_read_b64_tr_b16 v[58:59], v9 offset:20736
    ds_read_b128 v[132:135], v6 offset:0
    ds_read_b64_tr_b16 v[60:61], v9 offset:17408
    ds_read_b64_tr_b16 v[62:63], v9 offset:17664
    ds_read_b64_tr_b16 v[64:65], v9 offset:21504
    ds_read_b64_tr_b16 v[66:67], v9 offset:21760
    ds_read_b128 v[136:139], v7 offset:0
    ds_read_b64_tr_b16 v[68:69], v9 offset:18432
    ds_read_b64_tr_b16 v[70:71], v9 offset:18688
    ds_read_b64_tr_b16 v[72:73], v9 offset:22528
    ds_read_b64_tr_b16 v[74:75], v9 offset:22784
    ds_read_b128 v[140:143], v8 offset:0
    ds_read_b64_tr_b16 v[76:77], v9 offset:19456
    ds_read_b64_tr_b16 v[78:79], v9 offset:19712
    ds_read_b64_tr_b16 v[80:81], v9 offset:23552
    ds_read_b64_tr_b16 v[82:83], v9 offset:23808
    s_waitcnt lgkmcnt(0)
    s_cmp_lt_u32 s10, 2
    s_cbranch_scc1 G_WA0
    s_waitcnt vmcnt(22)
G_WA0:
    s_waitcnt vmcnt(26)
    s_barrier
    v_mfma_f32_32x32x16_bf16 v[20:35], v[52:55], v[128:131], 0
    ds_read_b128 v[144:147], v5 offset:24576
    ds_read_b64_tr_b16 v[84:85], v10 offset:8192
    ds_read_b64_tr_b16 v[86:87], v10 offset:8448
    ds_read_b64_tr_b16 v[88:89], v10 offset:12288
    ds_read_b64_tr_b16 v[90:91], v10 offset:12544
    ds_read_b128 v[148:151], v6 offset:24576
    ds_read_b64_tr_b16 v[92:93], v10 offset:9216
    v_mfma_f32_32x32x16_bf16 v[36:51], v[128:131], v[56:59], 0
    ds_read_b64_tr_b16 v[94:95], v10 offset:9472
    ds_read_b64_tr_b16 v[96:97], v10 offset:13312
    ds_read_b64_tr_b16 v[98:99], v10 offset:13568
    ds_read_b128 v[152:155], v7 offset:24576
    ds_read_b64_tr_b16 v[100:101], v10 offset:10240
    ds_read_b64_tr_b16 v[102:103], v10 offset:10496
    ds_read_b64_tr_b16 v[104:105], v10 offset:14336
    v_mfma_f32_32x32x16_bf16 v[20:35], v[60:63], v[132:135], v[20:35]
    ds_read_b64_tr_b16 v[106:107], v10 offset:14592
    ds_read_b128 v[156:159], v8 offset:24576
    ds_read_b64_tr_b16 v[108:109], v10 offset:11264
    ds_read_b64_tr_b16 v[110:111], v10 offset:11520
    ds_read_b64_tr_b16 v[112:113], v10 offset:15360
    ds_read_b64_tr_b16 v[114:115], v10 offset:15616
    s_add_u32 s13, s9, 3
    s_and_b32 s13, s13, 7
    s_lshl_b32 s11, s13, 7
    s_add_u32 m0, s14, 0
    s_add_u32 s12, s11, 7168
    buffer_load_dwordx4 v2, s[52:55], s11 offen lds
    v_mfma_f32_32x32x16_bf16 v[36:51], v[132:135], v[64:67], v[36:51]
    buffer_load_dwordx4 v3, s[52:55], s12 offen offset:1024 lds
    v_mfma_f32_32x32x16_bf16 v[20:35], v[68:71], v[136:139], v[20:35]
    s_add_u32 s12, s11, 21504
    s_add_u32 s11, s11, 14336
    s_mul_i32 s13, s13, 196608
    buffer_load_dwordx4 v2, s[52:55], s11 offen offset:2048 lds
    v_mfma_f32_32x32x16_bf16 v[36:51], v[136:139], v[72:75], v[36:51]
    buffer_load_dwordx4 v3, s[52:55], s12 offen offset:3072 lds
    v_mfma_f32_32x32x16_bf16 v[20:35], v[76:79], v[140:143], v[20:35]
    s_add_u32 m0, s15, 16384
    s_add_u32 s11, s13, 1024
    s_add_u32 s12, s13, 2048
    buffer_load_dwordx4 v4, s[56:59], s11 offen lds
    v_mfma_f32_32x32x16_bf16 v[36:51], v[140:143], v[80:83], v[36:51]
    s_add_u32 m0, s15, 20480
    s_nop 0
    buffer_load_dwordx4 v4, s[56:59], s12 offen lds
    s_waitcnt lgkmcnt(0)
    s_cmp_lt_u32 s10, 2
    s_cbranch_scc1 G_WA1
    s_waitcnt vmcnt(6)
G_WA1:
    s_waitcnt vmcnt(10)
    s_barrier
    v_mfma_f32_32x32x16_bf16 v[20:35], v[84:87], v[144:147], v[20:35]
    ds_read_b128 v[160:163], v5 offset:49152
    ds_read_b64_tr_b16 v[52:53], v10 offset:32768
    ds_read_b64_tr_b16 v[54:55], v10 offset:33024
    ds_read_b64_tr_b16 v[56:57], v10 offset:36864
    ds_read_b64_tr_b16 v[58:59], v10 offset:37120
    ds_read_b128 v[164:167], v6 offset:49152
    ds_read_b64_tr_b16 v[60:61], v10 offset:33792
    v_mfma_f32_32x32x16_bf16 v[36:51], v[144:147], v[88:91], v[36:51]
    ds_read_b64_tr_b16 v[62:63], v10 offset:34048
    ds_read_b64_tr_b16 v[64:65], v10 offset:37888
    ds_read_b64_tr_b16 v[66:67], v10 offset:38144
    ds_read_b128 v[168:171], v7 offset:49152
    ds_read_b64_tr_b16 v[68:69], v10 offset:34816
    ds_read_b64_tr_b16 v[70:71], v10 offset:35072
    ds_read_b64_tr_b16 v[72:73], v10 offset:38912
    v_mfma_f32_32x32x16_bf16 v[20:35], v[92:95], v[148:151], v[20:35]
    ds_read_b64_tr_b16 v[74:75], v10 offset:39168
    ds_read_b128 v[172:175], v8 offset:49152
    ds_read_b64_tr_b16 v[76:77], v10 offset:35840
    ds_read_b64_tr_b16 v[78:79], v10 offset:36096
    ds_read_b64_tr_b16 v[80:81], v10 offset:39936
    ds_read_b64_tr_b16 v[82:83], v10 offset:40192
    s_add_u32 s13, s9, 4
    s_and_b32 s13, s13, 7
    s_lshl_b32 s11, s13, 7
    s_add_u32 m0, s14, 24576
    s_add_u32 s12, s11, 7168
    buffer_load_dwordx4 v2, s[52:55], s11 offen lds
    v_mfma_f32_32x32x16_bf16 v[36:51], v[148:151], v[96:99], v[36:51]
    buffer_load_dwordx4 v3, s[52:55], s12 offen offset:1024 lds
    v_mfma_f32_32x32x16_bf16 v[20:35], v[100:103], v[152:155], v[20:35]
    s_add_u32 s12, s11, 21504
    s_add_u32 s11, s11, 14336
    s_mul_i32 s13, s13, 196608
    buffer_load_dwordx4 v2, s[52:55], s11 offen offset:2048 lds
    v_mfma_f32_32x32x16_bf16 v[36:51], v[152:155], v[104:107], v[36:51]
    buffer_load_dwordx4 v3, s[52:55], s12 offen offset:3072 lds
    v_mfma_f32_32x32x16_bf16 v[20:35], v[108:111], v[156:159], v[20:35]
    s_add_u32 m0, s15, 40960
    s_add_u32 s11, s13, 1024
    s_add_u32 s12, s13, 2048
    buffer_load_dwordx4 v4, s[56:59], s11 offen lds
    v_mfma_f32_32x32x16_bf16 v[36:51], v[156:159], v[112:115], v[36:51]
    s_add_u32 m0, s15, 45056
    s_nop 0
    buffer_load_dwordx4 v4, s[56:59], s12 offen lds
    v_bfe_u32 v120, v1, 2, 1
    v_mul_u32_u24 v120, 0x8000, v120
    v_lshl_or_b32 v120, v120, 16, v120
    v_lshl_or_b32 v12, v241, 16, v240
    v_xor_b32 v12, v120, v12
    v_lshl_or_b32 v13, v243, 16, v242
    v_xor_b32 v13, v120, v13
    v_lshl_or_b32 v14, v245, 16, v244
    v_xor_b32 v14, v120, v14
    v_lshl_or_b32 v15, v247, 16, v246
    v_xor_b32 v15, v120, v15
    v_lshl_or_b32 v16, v249, 16, v248
    v_xor_b32 v16, v120, v16
    v_lshl_or_b32 v17, v251, 16, v250
    v_xor_b32 v17, v120, v17
    v_lshl_or_b32 v18, v253, 16, v252
    v_xor_b32 v18, v120, v18
    v_lshl_or_b32 v19, v255, 16, v254
    v_xor_b32 v19, v120, v19
    s_waitcnt lgkmcnt(0)
    s_waitcnt vmcnt(6)
    s_cmp_lt_u32 s10, 2
    s_cbranch_scc0 G_NPX
    v_add_u32 v0, 1, v0
    s_mov_b64 exec, 0xff
    buffer_store_dword v0, v125, s[60:63], s6 offen sc1
    s_mov_b64 exec, -1
G_NPX:
    s_barrier
    v_mfma_f32_32x32x16_bf16 v[20:35], v[52:55], v[160:163], v[20:35]
    ds_read_b128 v[176:179], v5 offset:0
    ds_read_b64_tr_b16 v[84:85], v9 offset:16384
    ds_read_b64_tr_b16 v[86:87], v9 offset:16640
    ds_read_b64_tr_b16 v[88:89], v9 offset:20480
    ds_read_b64_tr_b16 v[90:91], v9 offset:20736
    ds_read_b128 v[180:183], v6 offset:0
    ds_read_b64_tr_b16 v[92:93], v9 offset:17408
    v_mfma_f32_32x32x16_bf16 v[36:51], v[160:163], v[56:59], v[36:51]
    ds_read_b64_tr_b16 v[94:95], v9 offset:17664
    ds_read_b64_tr_b16 v[96:97], v9 offset:21504
    ds_read_b64_tr_b16 v[98:99], v9 offset:21760
    ds_read_b128 v[184:187], v7 offset:0
    ds_read_b64_tr_b16 v[100:101], v9 offset:18432
    ds_read_b64_tr_b16 v[102:103], v9 offset:18688
    ds_read_b64_tr_b16 v[104:105], v9 offset:22528
    v_mfma_f32_32x32x16_bf16 v[20:35], v[60:63], v[164:167], v[20:35]
    ds_read_b64_tr_b16 v[106:107], v9 offset:22784
    ds_read_b128 v[188:191], v8 offset:0
    ds_read_b64_tr_b16 v[108:109], v9 offset:19456
    ds_read_b64_tr_b16 v[110:111], v9 offset:19712
    ds_read_b64_tr_b16 v[112:113], v9 offset:23552
    ds_read_b64_tr_b16 v[114:115], v9 offset:23808
    s_add_u32 s13, s9, 5
    s_and_b32 s13, s13, 7
    s_lshl_b32 s11, s13, 7
    s_add_u32 m0, s14, 49152
    s_add_u32 s12, s11, 7168
    buffer_load_dwordx4 v2, s[52:55], s11 offen lds
    v_mfma_f32_32x32x16_bf16 v[36:51], v[164:167], v[64:67], v[36:51]
    buffer_load_dwordx4 v3, s[52:55], s12 offen offset:1024 lds
    v_mfma_f32_32x32x16_bf16 v[20:35], v[68:71], v[168:171], v[20:35]
    s_add_u32 s12, s11, 21504
    s_add_u32 s11, s11, 14336
    s_mul_i32 s13, s13, 196608
    buffer_load_dwordx4 v2, s[52:55], s11 offen offset:2048 lds
    v_mfma_f32_32x32x16_bf16 v[36:51], v[168:171], v[72:75], v[36:51]
    buffer_load_dwordx4 v3, s[52:55], s12 offen offset:3072 lds
    v_mfma_f32_32x32x16_bf16 v[20:35], v[76:79], v[172:175], v[20:35]
    s_add_u32 m0, s15, 65536
    s_add_u32 s11, s13, 1024
    s_add_u32 s12, s13, 2048
    buffer_load_dwordx4 v4, s[56:59], s11 offen lds
    v_mfma_f32_32x32x16_bf16 v[36:51], v[172:175], v[80:83], v[36:51]
    s_add_u32 m0, s15, 69632
    s_nop 0
    buffer_load_dwordx4 v4, s[56:59], s12 offen lds
    s_waitcnt lgkmcnt(0)
    s_waitcnt vmcnt(6)
    s_barrier
    v_mfma_f32_32x32x16_bf16 v[20:35], v[84:87], v[176:179], v[20:35]
    ds_read_b128 v[192:195], v5 offset:24576
    ds_read_b64_tr_b16 v[52:53], v10 offset:8192
    ds_read_b64_tr_b16 v[54:55], v10 offset:8448
    ds_read_b64_tr_b16 v[56:57], v10 offset:12288
    ds_read_b64_tr_b16 v[58:59], v10 offset:12544
    ds_read_b128 v[196:199], v6 offset:24576
    ds_read_b64_tr_b16 v[60:61], v10 offset:9216
    v_mfma_f32_32x32x16_bf16 v[36:51], v[176:179], v[88:91], v[36:51]
    ds_read_b64_tr_b16 v[62:63], v10 offset:9472
    ds_read_b64_tr_b16 v[64:65], v10 offset:13312
    ds_read_b64_tr_b16 v[66:67], v10 offset:13568
    ds_read_b128 v[200:203], v7 offset:24576
    ds_read_b64_tr_b16 v[68:69], v10 offset:10240
    ds_read_b64_tr_b16 v[70:71], v10 offset:10496
    ds_read_b64_tr_b16 v[72:73], v10 offset:14336
    v_mfma_f32_32x32x16_bf16 v[20:35], v[92:95], v[180:183], v[20:35]
    ds_read_b64_tr_b16 v[74:75], v10 offset:14592
    ds_read_b128 v[204:207], v8 offset:24576
    ds_read_b64_tr_b16 v[76:77], v10 offset:11264
    ds_read_b64_tr_b16 v[78:79], v10 offset:11520
    ds_read_b64_tr_b16 v[80:81], v10 offset:15360
    ds_read_b64_tr_b16 v[82:83], v10 offset:15616
    s_add_u32 s13, s9, 6
    s_and_b32 s13, s13, 7
    s_lshl_b32 s11, s13, 7
    s_add_u32 m0, s14, 0
    s_add_u32 s12, s11, 7168
    buffer_load_dwordx4 v2, s[52:55], s11 offen lds
    v_mfma_f32_32x32x16_bf16 v[36:51], v[180:183], v[96:99], v[36:51]
    buffer_load_dwordx4 v3, s[52:55], s12 offen offset:1024 lds
    v_mfma_f32_32x32x16_bf16 v[20:35], v[100:103], v[184:187], v[20:35]
    s_add_u32 s12, s11, 21504
    s_add_u32 s11, s11, 14336
    s_mul_i32 s13, s13, 196608
    buffer_load_dwordx4 v2, s[52:55], s11 offen offset:2048 lds
    v_mfma_f32_32x32x16_bf16 v[36:51], v[184:187], v[104:107], v[36:51]
    buffer_load_dwordx4 v3, s[52:55], s12 offen offset:3072 lds
    v_mfma_f32_32x32x16_bf16 v[20:35], v[108:111], v[188:191], v[20:35]
    s_add_u32 m0, s15, 16384
    s_add_u32 s11, s13, 1024
    s_add_u32 s12, s13, 2048
    buffer_load_dwordx4 v4, s[56:59], s11 offen lds
    v_mfma_f32_32x32x16_bf16 v[36:51], v[188:191], v[112:115], v[36:51]
    s_add_u32 m0, s15, 20480
    s_nop 0
    buffer_load_dwordx4 v4, s[56:59], s12 offen lds
    s_waitcnt lgkmcnt(0)
    s_waitcnt vmcnt(6)
    s_barrier
    v_mfma_f32_32x32x16_bf16 v[20:35], v[52:55], v[192:195], v[20:35]
    ds_read_b128 v[208:211], v5 offset:49152
    ds_read_b64_tr_b16 v[84:85], v10 offset:32768
    ds_read_b64_tr_b16 v[86:87], v10 offset:33024
    ds_read_b64_tr_b16 v[88:89], v10 offset:36864
    ds_read_b64_tr_b16 v[90:91], v10 offset:37120
    ds_read_b128 v[212:215], v6 offset:49152
    ds_read_b64_tr_b16 v[92:93], v10 offset:33792
    v_mfma_f32_32x32x16_bf16 v[36:51], v[192:195], v[56:59], v[36:51]
    ds_read_b64_tr_b16 v[94:95], v10 offset:34048
    ds_read_b64_tr_b16 v[96:97], v10 offset:37888
    ds_read_b64_tr_b16 v[98:99], v10 offset:38144
    ds_read_b128 v[216:219], v7 offset:49152
    ds_read_b64_tr_b16 v[100:101], v10 offset:34816
    ds_read_b64_tr_b16 v[102:103], v10 offset:35072
    ds_read_b64_tr_b16 v[104:105], v10 offset:38912
    v_mfma_f32_32x32x16_bf16 v[20:35], v[60:63], v[196:199], v[20:35]
    ds_read_b64_tr_b16 v[106:107], v10 offset:39168
    ds_read_b128 v[220:223], v8 offset:49152
    ds_read_b64_tr_b16 v[108:109], v10 offset:35840
    ds_read_b64_tr_b16 v[110:111], v10 offset:36096
    ds_read_b64_tr_b16 v[112:113], v10 offset:39936
    ds_read_b64_tr_b16 v[114:115], v10 offset:40192
    s_add_u32 s13, s9, 7
    s_and_b32 s13, s13, 7
    s_lshl_b32 s11, s13, 7
    s_add_u32 m0, s14, 24576
    s_add_u32 s12, s11, 7168
    buffer_load_dwordx4 v2, s[52:55], s11 offen lds
    v_mfma_f32_32x32x16_bf16 v[36:51], v[196:199], v[64:67], v[36:51]
    buffer_load_dwordx4 v3, s[52:55], s12 offen offset:1024 lds
    v_mfma_f32_32x32x16_bf16 v[20:35], v[68:71], v[200:203], v[20:35]
    s_add_u32 s12, s11, 21504
    s_add_u32 s11, s11, 14336
    s_mul_i32 s13, s13, 196608
    buffer_load_dwordx4 v2, s[52:55], s11 offen offset:2048 lds
    v_mfma_f32_32x32x16_bf16 v[36:51], v[200:203], v[72:75], v[36:51]
    buffer_load_dwordx4 v3, s[52:55], s12 offen offset:3072 lds
    v_mfma_f32_32x32x16_bf16 v[20:35], v[76:79], v[204:207], v[20:35]
    s_add_u32 m0, s15, 40960
    s_add_u32 s11, s13, 1024
    s_add_u32 s12, s13, 2048
    buffer_load_dwordx4 v4, s[56:59], s11 offen lds
    v_mfma_f32_32x32x16_bf16 v[36:51], v[204:207], v[80:83], v[36:51]
    s_add_u32 m0, s15, 45056
    s_nop 0
    buffer_load_dwordx4 v4, s[56:59], s12 offen lds
    s_waitcnt lgkmcnt(0)
    s_waitcnt vmcnt(6)
    s_barrier
    v_mfma_f32_32x32x16_bf16 v[20:35], v[84:87], v[208:211], v[20:35]
    ds_read_b128 v[224:227], v5 offset:0
    ds_read_b64_tr_b16 v[52:53], v9 offset:16384
    ds_read_b64_tr_b16 v[54:55], v9 offset:16640
    ds_read_b64_tr_b16 v[56:57], v9 offset:20480
    ds_read_b64_tr_b16 v[58:59], v9 offset:20736
    ds_read_b128 v[228:231], v6 offset:0
    ds_read_b64_tr_b16 v[60:61], v9 offset:17408
    v_mfma_f32_32x32x16_bf16 v[36:51], v[208:211], v[88:91], v[36:51]
    ds_read_b64_tr_b16 v[62:63], v9 offset:17664
    ds_read_b64_tr_b16 v[64:65], v9 offset:21504
    ds_read_b64_tr_b16 v[66:67], v9 offset:21760
    ds_read_b128 v[232:235], v7 offset:0
    ds_read_b64_tr_b16 v[68:69], v9 offset:18432
    ds_read_b64_tr_b16 v[70:71], v9 offset:18688
    ds_read_b64_tr_b16 v[72:73], v9 offset:22528
    v_mfma_f32_32x32x16_bf16 v[20:35], v[92:95], v[212:215], v[20:35]
    ds_read_b64_tr_b16 v[74:75], v9 offset:22784
    ds_read_b128 v[236:239], v8 offset:0
    ds_read_b64_tr_b16 v[76:77], v9 offset:19456
    ds_read_b64_tr_b16 v[78:79], v9 offset:19712
    ds_read_b64_tr_b16 v[80:81], v9 offset:23552
    ds_read_b64_tr_b16 v[82:83], v9 offset:23808
    s_add_u32 s13, s9, 0
    s_and_b32 s13, s13, 7
    s_add_u32 m0, s15, 49152
    s_mul_i32 s11, s13, 196608
    buffer_load_dwordx4 v4, s[56:59], s11 offen lds
    v_mfma_f32_32x32x16_bf16 v[36:51], v[212:215], v[96:99], v[36:51]
    s_add_u32 s13, s9, 1
    s_and_b32 s13, s13, 7
    s_add_u32 m0, s15, 53248
    s_mul_i32 s11, s13, 196608
    buffer_load_dwordx4 v4, s[56:59], s11 offen lds
    v_mfma_f32_32x32x16_bf16 v[20:35], v[100:103], v[216:219], v[20:35]
    s_add_u32 s13, s9, 2
    s_and_b32 s13, s13, 7
    s_add_u32 m0, s15, 57344
    s_mul_i32 s11, s13, 196608
    buffer_load_dwordx4 v4, s[56:59], s11 offen lds
    v_mfma_f32_32x32x16_bf16 v[36:51], v[216:219], v[104:107], v[36:51]
    s_add_u32 s13, s9, 3
    s_and_b32 s13, s13, 7
    s_add_u32 m0, s15, 61440
    s_mul_i32 s11, s13, 196608
    buffer_load_dwordx4 v4, s[56:59], s11 offen lds
    v_mfma_f32_32x32x16_bf16 v[20:35], v[108:111], v[220:223], v[20:35]
    s_add_u32 s13, s9, 4
    s_and_b32 s13, s13, 7
    s_add_u32 m0, s15, 65536
    s_mul_i32 s11, s13, 196608
    buffer_load_dwordx4 v4, s[56:59], s11 offen lds
    v_mfma_f32_32x32x16_bf16 v[36:51], v[220:223], v[112:115], v[36:51]
    s_add_u32 s13, s9, 5
    s_and_b32 s13, s13, 7
    s_add_u32 m0, s15, 69632
    s_mul_i32 s11, s13, 196608
    buffer_load_dwordx4 v4, s[56:59], s11 offen lds
    s_waitcnt lgkmcnt(0)
    s_waitcnt vmcnt(6)
    s_barrier
    v_mfma_f32_32x32x16_bf16 v[20:35], v[52:55], v[224:227], v[20:35]
    ds_read_b128 v[240:243], v5 offset:24576
    ds_read_b64_tr_b16 v[84:85], v10 offset:8192
    ds_read_b64_tr_b16 v[86:87], v10 offset:8448
    ds_read_b64_tr_b16 v[88:89], v10 offset:12288
    ds_read_b64_tr_b16 v[90:91], v10 offset:12544
    ds_read_b128 v[244:247], v6 offset:24576
    ds_read_b64_tr_b16 v[92:93], v10 offset:9216
    v_mfma_f32_32x32x16_bf16 v[36:51], v[224:227], v[56:59], v[36:51]
    ds_read_b64_tr_b16 v[94:95], v10 offset:9472
    ds_read_b64_tr_b16 v[96:97], v10 offset:13312
    ds_read_b64_tr_b16 v[98:99], v10 offset:13568
    ds_read_b128 v[248:251], v7 offset:24576
    ds_read_b64_tr_b16 v[100:101], v10 offset:10240
    ds_read_b64_tr_b16 v[102:103], v10 offset:10496
    ds_read_b64_tr_b16 v[104:105], v10 offset:14336
    v_mfma_f32_32x32x16_bf16 v[20:35], v[60:63], v[228:231], v[20:35]
    ds_read_b64_tr_b16 v[106:107], v10 offset:14592
    ds_read_b128 v[252:255], v8 offset:24576
    ds_read_b64_tr_b16 v[108:109], v10 offset:11264
    ds_read_b64_tr_b16 v[110:111], v10 offset:11520
    ds_read_b64_tr_b16 v[112:113], v10 offset:15360
    ds_read_b64_tr_b16 v[114:115], v10 offset:15616
    s_add_u32 s13, s9, 6
    s_and_b32 s13, s13, 7
    s_add_u32 m0, s15, 0
    s_mul_i32 s11, s13, 196608
    buffer_load_dwordx4 v4, s[56:59], s11 offen lds
    v_mfma_f32_32x32x16_bf16 v[36:51], v[228:231], v[64:67], v[36:51]
    s_add_u32 s13, s9, 7
    s_and_b32 s13, s13, 7
    s_add_u32 m0, s15, 4096
    s_mul_i32 s11, s13, 196608
    buffer_load_dwordx4 v4, s[56:59], s11 offen lds
    v_mfma_f32_32x32x16_bf16 v[20:35], v[68:71], v[232:235], v[20:35]
    v_mfma_f32_32x32x16_bf16 v[36:51], v[232:235], v[72:75], v[36:51]
    v_mfma_f32_32x32x16_bf16 v[20:35], v[76:79], v[236:239], v[20:35]
    v_mfma_f32_32x32x16_bf16 v[36:51], v[236:239], v[80:83], v[36:51]
    s_lshl_b32 s11, s4, 14
    s_and_b32 s12, s10, 1
    s_lshl_b32 s12, s12, 13
    s_add_u32 s11, s11, s12
    v_lshlrev_b32 v120, 7, v1
    v_add_u32 v120, s11, v120
    global_load_dword v3, v120, s[22:23]
    s_waitcnt lgkmcnt(0)
    s_barrier
    v_mfma_f32_32x32x16_bf16 v[20:35], v[84:87], v[240:243], v[20:35]
    v_mfma_f32_32x32x16_bf16 v[36:51], v[240:243], v[88:91], v[36:51]
    v_mfma_f32_32x32x16_bf16 v[20:35], v[92:95], v[244:247], v[20:35]
    v_mfma_f32_32x32x16_bf16 v[36:51], v[244:247], v[96:99], v[36:51]
    v_mfma_f32_32x32x16_bf16 v[20:35], v[100:103], v[248:251], v[20:35]
    v_mfma_f32_32x32x16_bf16 v[36:51], v[248:251], v[104:107], v[36:51]
    v_mfma_f32_32x32x16_bf16 v[20:35], v[108:111], v[252:255], v[20:35]
    v_mfma_f32_32x32x16_bf16 v[36:51], v[252:255], v[112:115], v[36:51]
    s_mov_b64 exec, 0xff
    buffer_load_dword v127, v126, s[64:67], 0 offen offset:128 sc1
    s_mov_b64 exec, -1
    v_mov_b32 v116, 0x3fb8aa3b
    s_mov_b32 s26, 0x0000ffff
    s_mov_b32 s27, 0x0000ffff
    s_mov_b32 s28, 0xffff0000
    s_mov_b32 s29, 0xffff0000
    s_mul_i32 s11, s10, 6144
    s_add_u32 s11, s11, 24576
    v_and_b32 v124, 31, v1
    v_lshlrev_b32 v124, 6, v124
    v_lshrrev_b32 v125, 5, v1
    v_lshl_add_u32 v124, v125, 5, v124
    v_add_u32 v5, s11, v124
    v_bfe_u32 v124, v1, 2, 2
    v_lshl_add_u32 v124, v125, 2, v124
    v_lshlrev_b32 v124, 6, v124
    v_bfe_u32 v125, v1, 4, 1
    v_lshl_add_u32 v124, v125, 5, v124
    v_and_b32 v125, 3, v1
    v_lshl_add_u32 v124, v125, 3, v124
    v_add_u32 v6, s11, v124
    v_lshlrev_b32 v124, 4, v1
    v_add_u32 v7, s11, v124
    s_lshl_b32 s11, s10, 10
    s_add_u32 s11, s11, 24576
    v_add_u32 v8, s11, v124
    v_cvt_pk_bf16_f32 v52, v20, v21
    v_cvt_pk_bf16_f32 v53, v22, v23
    v_cvt_pk_bf16_f32 v54, v24, v25
    v_cvt_pk_bf16_f32 v55, v26, v27
    v_cvt_pk_bf16_f32 v56, v28, v29
    v_cvt_pk_bf16_f32 v57, v30, v31
    v_cvt_pk_bf16_f32 v58, v32, v33
    v_cvt_pk_bf16_f32 v59, v34, v35
    v_mfma_f32_32x32x16_bf16 v[84:99], v[12:15], v[52:55], 0
    s_nop 0
    v_mfma_f32_32x32x16_bf16 v[100:115], v[16:19], v[56:59], 0
    v_cvt_pk_bf16_f32 v60, v36, v37
    v_cvt_pk_bf16_f32 v61, v38, v39
    v_cvt_pk_bf16_f32 v62, v40, v41
    v_cvt_pk_bf16_f32 v63, v42, v43
    v_cvt_pk_bf16_f32 v64, v44, v45
    v_cvt_pk_bf16_f32 v65, v46, v47
    v_cvt_pk_bf16_f32 v66, v48, v49
    v_cvt_pk_bf16_f32 v67, v50, v51
    v_mov_b32 v124, 0x3f803f80
    v_cndmask_b32 v20, v124, v60, s[26:27]
    v_cndmask_b32 v21, v124, v61, s[26:27]
    v_cndmask_b32 v22, v124, v62, s[26:27]
    v_cndmask_b32 v23, v124, v63, s[26:27]
    v_cndmask_b32 v24, v124, v64, s[26:27]
    v_cndmask_b32 v25, v124, v65, s[26:27]
    v_cndmask_b32 v26, v124, v66, s[26:27]
    v_cndmask_b32 v27, v124, v67, s[26:27]
    v_cndmask_b32 v28, v124, v60, s[28:29]
    v_cndmask_b32 v29, v124, v61, s[28:29]
    v_cndmask_b32 v30, v124, v62, s[28:29]
    v_cndmask_b32 v31, v124, v63, s[28:29]
    v_cndmask_b32 v32, v124, v64, s[28:29]
    v_cndmask_b32 v33, v124, v65, s[28:29]
    v_cndmask_b32 v34, v124, v66, s[28:29]
    v_cndmask_b32 v35, v124, v67, s[28:29]
    v_max3_f32 v118, v84, v85, v86
    v_max3_f32 v36, v100, v101, v102
    v_max3_f32 v119, v87, v88, v89
    v_max3_f32 v37, v103, v104, v105
    v_max3_f32 v118, v118, v90, v91
    v_max3_f32 v36, v36, v106, v107
    v_max3_f32 v119, v119, v92, v93
    v_max3_f32 v37, v37, v108, v109
    v_max3_f32 v118, v118, v94, v95
    v_max3_f32 v36, v36, v110, v111
    v_max3_f32 v119, v119, v96, v97
    v_max3_f32 v37, v37, v112, v113
    v_max3_f32 v118, v118, v98, v99
    v_max3_f32 v36, v36, v114, v115
    v_max_f32 v118, v118, v119
    v_max_f32 v36, v36, v37
    v_mul_f32 v118, v116, v118
    v_mul_f32 v36, v116, v36
    v_pk_fma_f32 v[84:85], v[84:85], v[116:117], v[118:119] op_sel_hi:[1,0,0] neg_lo:[0,0,1] neg_hi:[0,0,1]
    v_pk_fma_f32 v[100:101], v[100:101], v[116:117], v[36:37] op_sel_hi:[1,0,0] neg_lo:[0,0,1] neg_hi:[0,0,1]
    v_pk_fma_f32 v[86:87], v[86:87], v[116:117], v[118:119] op_sel_hi:[1,0,0] neg_lo:[0,0,1] neg_hi:[0,0,1]
    v_pk_fma_f32 v[102:103], v[102:103], v[116:117], v[36:37] op_sel_hi:[1,0,0] neg_lo:[0,0,1] neg_hi:[0,0,1]
    v_pk_fma_f32 v[88:89], v[88:89], v[116:117], v[118:119] op_sel_hi:[1,0,0] neg_lo:[0,0,1] neg_hi:[0,0,1]
    v_pk_fma_f32 v[104:105], v[104:105], v[116:117], v[36:37] op_sel_hi:[1,0,0] neg_lo:[0,0,1] neg_hi:[0,0,1]
    v_pk_fma_f32 v[90:91], v[90:91], v[116:117], v[118:119] op_sel_hi:[1,0,0] neg_lo:[0,0,1] neg_hi:[0,0,1]
    v_pk_fma_f32 v[106:107], v[106:107], v[116:117], v[36:37] op_sel_hi:[1,0,0] neg_lo:[0,0,1] neg_hi:[0,0,1]
    v_pk_fma_f32 v[92:93], v[92:93], v[116:117], v[118:119] op_sel_hi:[1,0,0] neg_lo:[0,0,1] neg_hi:[0,0,1]
    v_pk_fma_f32 v[108:109], v[108:109], v[116:117], v[36:37] op_sel_hi:[1,0,0] neg_lo:[0,0,1] neg_hi:[0,0,1]
    v_pk_fma_f32 v[94:95], v[94:95], v[116:117], v[118:119] op_sel_hi:[1,0,0] neg_lo:[0,0,1] neg_hi:[0,0,1]
    v_pk_fma_f32 v[110:111], v[110:111], v[116:117], v[36:37] op_sel_hi:[1,0,0] neg_lo:[0,0,1] neg_hi:[0,0,1]
    v_pk_fma_f32 v[96:97], v[96:97], v[116:117], v[118:119] op_sel_hi:[1,0,0] neg_lo:[0,0,1] neg_hi:[0,0,1]
    v_pk_fma_f32 v[112:113], v[112:113], v[116:117], v[36:37] op_sel_hi:[1,0,0] neg_lo:[0,0,1] neg_hi:[0,0,1]
    v_pk_fma_f32 v[98:99], v[98:99], v[116:117], v[118:119] op_sel_hi:[1,0,0] neg_lo:[0,0,1] neg_hi:[0,0,1]
    v_pk_fma_f32 v[114:115], v[114:115], v[116:117], v[36:37] op_sel_hi:[1,0,0] neg_lo:[0,0,1] neg_hi:[0,0,1]
    v_exp_f32 v84, v84
    v_exp_f32 v100, v100
    v_exp_f32 v85, v85
    v_exp_f32 v101, v101
    v_exp_f32 v86, v86
    v_exp_f32 v102, v102
    v_exp_f32 v87, v87
    v_exp_f32 v103, v103
    v_exp_f32 v88, v88
    v_exp_f32 v104, v104
    v_exp_f32 v89, v89
    v_exp_f32 v105, v105
    v_exp_f32 v90, v90
    v_exp_f32 v106, v106
    v_exp_f32 v91, v91
    v_exp_f32 v107, v107
    v_exp_f32 v92, v92
    v_exp_f32 v108, v108
    v_exp_f32 v93, v93
    v_exp_f32 v109, v109
    v_exp_f32 v94, v94
    v_exp_f32 v110, v110
    v_exp_f32 v95, v95
    v_exp_f32 v111, v111
    v_exp_f32 v96, v96
    v_exp_f32 v112, v112
    v_exp_f32 v97, v97
    v_exp_f32 v113, v113
    v_exp_f32 v98, v98
    v_exp_f32 v114, v114
    v_exp_f32 v99, v99
    v_exp_f32 v115, v115
    v_pk_add_f32 v[120:121], v[84:85], v[86:87]
    v_pk_add_f32 v[38:39], v[100:101], v[102:103]
    v_pk_add_f32 v[122:123], v[88:89], v[90:91]
    v_pk_add_f32 v[40:41], v[104:105], v[106:107]
    v_pk_add_f32 v[120:121], v[120:121], v[92:93]
    v_pk_add_f32 v[38:39], v[38:39], v[108:109]
    v_pk_add_f32 v[122:123], v[122:123], v[94:95]
    v_pk_add_f32 v[40:41], v[40:41], v[110:111]
    v_pk_add_f32 v[120:121], v[120:121], v[96:97]
    v_pk_add_f32 v[38:39], v[38:39], v[112:113]
    v_pk_add_f32 v[122:123], v[122:123], v[98:99]
    v_pk_add_f32 v[40:41], v[40:41], v[114:115]
    v_pk_add_f32 v[120:121], v[120:121], v[122:123]
    v_pk_add_f32 v[38:39], v[38:39], v[40:41]
    v_add_f32 v120, v120, v121
    v_add_f32 v38, v38, v39
    v_rcp_f32 v120, v120
    v_rcp_f32 v38, v38
    v_pk_mul_f32 v[84:85], v[84:85], v[120:121] op_sel_hi:[1,0]
    v_pk_mul_f32 v[100:101], v[100:101], v[38:39] op_sel_hi:[1,0]
    v_pk_mul_f32 v[86:87], v[86:87], v[120:121] op_sel_hi:[1,0]
    v_pk_mul_f32 v[102:103], v[102:103], v[38:39] op_sel_hi:[1,0]
    v_pk_mul_f32 v[88:89], v[88:89], v[120:121] op_sel_hi:[1,0]
    v_pk_mul_f32 v[104:105], v[104:105], v[38:39] op_sel_hi:[1,0]
    v_pk_mul_f32 v[90:91], v[90:91], v[120:121] op_sel_hi:[1,0]
    v_pk_mul_f32 v[106:107], v[106:107], v[38:39] op_sel_hi:[1,0]
    v_pk_mul_f32 v[92:93], v[92:93], v[120:121] op_sel_hi:[1,0]
    v_pk_mul_f32 v[108:109], v[108:109], v[38:39] op_sel_hi:[1,0]
    v_pk_mul_f32 v[94:95], v[94:95], v[120:121] op_sel_hi:[1,0]
    v_pk_mul_f32 v[110:111], v[110:111], v[38:39] op_sel_hi:[1,0]
    v_pk_mul_f32 v[96:97], v[96:97], v[120:121] op_sel_hi:[1,0]
    v_pk_mul_f32 v[112:113], v[112:113], v[38:39] op_sel_hi:[1,0]
    v_pk_mul_f32 v[98:99], v[98:99], v[120:121] op_sel_hi:[1,0]
    v_pk_mul_f32 v[114:115], v[114:115], v[38:39] op_sel_hi:[1,0]
    v_cvt_pk_bf16_f32 v68, v84, v85
    v_cvt_pk_bf16_f32 v76, v100, v101
    v_cvt_pk_bf16_f32 v69, v86, v87
    v_cvt_pk_bf16_f32 v77, v102, v103
    v_cvt_pk_bf16_f32 v70, v88, v89
    v_cvt_pk_bf16_f32 v78, v104, v105
    v_cvt_pk_bf16_f32 v71, v90, v91
    v_cvt_pk_bf16_f32 v79, v106, v107
    v_cvt_pk_bf16_f32 v72, v92, v93
    v_cvt_pk_bf16_f32 v80, v108, v109
    v_cvt_pk_bf16_f32 v73, v94, v95
    v_cvt_pk_bf16_f32 v81, v110, v111
    v_cvt_pk_bf16_f32 v74, v96, v97
    v_cvt_pk_bf16_f32 v82, v112, v113
    v_cvt_pk_bf16_f32 v75, v98, v99
    v_cvt_pk_bf16_f32 v83, v114, v115
    ds_write_b128 v5, v[68:71]
    ds_write_b128 v5, v[72:75] offset:16
    ds_write_b128 v5, v[76:79] offset:2048
    ds_write_b128 v5, v[80:83] offset:2064
    ds_read_b64_tr_b16 v[52:53], v6 offset:0
    ds_read_b64_tr_b16 v[54:55], v6 offset:512
    ds_read_b64_tr_b16 v[56:57], v6 offset:1024
    ds_read_b64_tr_b16 v[58:59], v6 offset:1536
    ds_read_b64_tr_b16 v[60:61], v6 offset:2048
    ds_read_b64_tr_b16 v[62:63], v6 offset:2560
    ds_read_b64_tr_b16 v[64:65], v6 offset:3072
    ds_read_b64_tr_b16 v[66:67], v6 offset:3584
    s_waitcnt lgkmcnt(4)
    v_mfma_f32_32x32x16_bf16 v[84:99], v[20:23], v[52:55], 0
    v_mfma_f32_32x32x16_bf16 v[84:99], v[24:27], v[56:59], v[84:99]
    s_waitcnt lgkmcnt(0)
    v_mfma_f32_32x32x16_bf16 v[100:115], v[28:31], v[60:63], 0
    v_mfma_f32_32x32x16_bf16 v[100:115], v[32:35], v[64:67], v[100:115]
    s_lshl_b32 s34, s8, 1
    s_lshl_b32 s35, s34, 11
    s_lshl_b32 s11, s10, 10
    s_add_u32 s35, s35, s11
    s_add_u32 s35, s35, 8388608
    s_lshl_b32 s36, s34, 7
    s_add_u32 s36, s36, 8454144
    v_and_b32 v124, 31, v1
    v_lshlrev_b32 v124, 2, v124
    v_lshrrev_b32 v125, 5, v1
    v_lshlrev_b32 v123, 2, v1
    v_lshl_add_u32 v124, v125, 9, v124
    v_lshlrev_b32 v50, 2, v1
    s_mul_i32 s11, s10, 6144
    s_add_u32 s11, s11, 28672
    v_add_u32 v51, s11, v50
    v_add_u32 v50, 28672, v50
    s_mov_b32 s26, -1
    s_mov_b32 s27, 0
    ds_write_b128 v7, v[84:87]
    ds_write_b128 v7, v[88:91] offset:1024
    v_cndmask_b32 v49, v100, v92, s[26:27]
    ds_write_b128 v7, v[108:111] offset:2048
    ds_write_b128 v7, v[112:115] offset:3072
    ds_write_b32 v51, v49
    s_waitcnt lgkmcnt(0)
    s_waitcnt vmcnt(0)
    s_barrier
    ds_read_b128 v[84:87], v8 offset:0
    ds_read_b128 v[88:91], v8 offset:6144
    ds_read_b128 v[92:95], v8 offset:12288
    ds_read_b128 v[96:99], v8 offset:18432
    ds_read_b32 v100, v50 offset:0
    ds_read_b32 v101, v50 offset:6144
    ds_read_b32 v102, v50 offset:12288
    ds_read_b32 v103, v50 offset:18432
    s_mov_b32 s51, 0
    s_mov_b64 exec, 0xff
G_RDY:
    v_cmp_eq_u32 vcc, 0, v127
    s_nop 1
    s_cbranch_vccz G_RDYOK
    s_add_u32 s51, s51, 1
    s_cmp_gt_u32 s51, 100000
    s_cbranch_scc1 G_RDYOK
    s_sleep 16
    buffer_load_dword v127, v126, s[64:67], 0 offen offset:128 sc1
    s_waitcnt vmcnt(0)
    s_branch G_RDY
G_RDYOK:
    s_mov_b64 exec, -1
    s_waitcnt lgkmcnt(0)
    ds_read_b64_tr_b16 v[52:53], v10 offset:16384
    ds_read_b64_tr_b16 v[54:55], v10 offset:16640
    ds_read_b64_tr_b16 v[56:57], v10 offset:17408
    ds_read_b64_tr_b16 v[58:59], v10 offset:17664
    ds_read_b64_tr_b16 v[60:61], v10 offset:18432
    ds_read_b64_tr_b16 v[62:63], v10 offset:18688
    ds_read_b64_tr_b16 v[64:65], v10 offset:19456
    ds_read_b64_tr_b16 v[66:67], v10 offset:19712
    ds_read_b64_tr_b16 v[68:69], v10 offset:20480
    ds_read_b64_tr_b16 v[70:71], v10 offset:20736
    ds_read_b64_tr_b16 v[72:73], v10 offset:21504
    ds_read_b64_tr_b16 v[74:75], v10 offset:21760
    v_pk_add_f32 v[84:85], v[84:85], v[88:89]
    v_pk_add_f32 v[92:93], v[92:93], v[96:97]
    v_pk_add_f32 v[86:87], v[86:87], v[90:91]
    v_pk_add_f32 v[94:95], v[94:95], v[98:99]
    v_pk_add_f32 v[100:101], v[100:101], v[102:103]
    v_pk_add_f32 v[36:37], v[84:85], v[92:93]
    v_pk_add_f32 v[38:39], v[86:87], v[94:95]
    v_add_f32 v40, v100, v101
    s_waitcnt lgkmcnt(10)
    v_mfma_f32_32x32x16_bf16 v[20:35], v[52:55], v[128:131], 0
    ds_read_b64_tr_b16 v[76:77], v10 offset:22528
    ds_read_b64_tr_b16 v[78:79], v10 offset:22784
    buffer_atomic_add_f32 v36, v124, s[60:63], s35 offen offset:0
    s_waitcnt lgkmcnt(10)
    v_mfma_f32_32x32x16_bf16 v[100:115], v[56:59], v[132:135], 0
    ds_read_b64_tr_b16 v[80:81], v10 offset:23552
    ds_read_b64_tr_b16 v[82:83], v10 offset:23808
    buffer_atomic_add_f32 v37, v124, s[60:63], s35 offen offset:128
    s_waitcnt lgkmcnt(10)
    v_mfma_f32_32x32x16_bf16 v[20:35], v[60:63], v[136:139], v[20:35]
    ds_read_b64_tr_b16 v[52:53], v10 offset:24576
    ds_read_b64_tr_b16 v[54:55], v10 offset:24832
    buffer_atomic_add_f32 v38, v124, s[60:63], s35 offen offset:256
    s_waitcnt lgkmcnt(10)
    v_mfma_f32_32x32x16_bf16 v[100:115], v[64:67], v[140:143], v[100:115]
    ds_read_b64_tr_b16 v[56:57], v10 offset:25600
    ds_read_b64_tr_b16 v[58:59], v10 offset:25856
    buffer_atomic_add_f32 v39, v124, s[60:63], s35 offen offset:384
    s_waitcnt lgkmcnt(10)
    v_mfma_f32_32x32x16_bf16 v[20:35], v[68:71], v[144:147], v[20:35]
    ds_read_b64_tr_b16 v[60:61], v10 offset:26624
    ds_read_b64_tr_b16 v[62:63], v10 offset:26880
    s_cmp_eq_u32 s10, 3
    s_cbranch_scc0 G_NOZ
    buffer_atomic_add_f32 v40, v123, s[60:63], s36 offen
G_NOZ:
    s_waitcnt lgkmcnt(10)
    v_mfma_f32_32x32x16_bf16 v[100:115], v[72:75], v[148:151], v[100:115]
    ds_read_b64_tr_b16 v[64:65], v10 offset:27648
    ds_read_b64_tr_b16 v[66:67], v10 offset:27904
    s_waitcnt lgkmcnt(10)
    v_mfma_f32_32x32x16_bf16 v[20:35], v[76:79], v[152:155], v[20:35]
    ds_read_b64_tr_b16 v[68:69], v10 offset:28672
    ds_read_b64_tr_b16 v[70:71], v10 offset:28928
    s_waitcnt lgkmcnt(10)
    v_mfma_f32_32x32x16_bf16 v[100:115], v[80:83], v[156:159], v[100:115]
    ds_read_b64_tr_b16 v[72:73], v10 offset:29696
    ds_read_b64_tr_b16 v[74:75], v10 offset:29952
    s_waitcnt lgkmcnt(10)
    v_mfma_f32_32x32x16_bf16 v[20:35], v[52:55], v[160:163], v[20:35]
    ds_read_b64_tr_b16 v[76:77], v10 offset:30720
    ds_read_b64_tr_b16 v[78:79], v10 offset:30976
    s_waitcnt lgkmcnt(10)
    v_mfma_f32_32x32x16_bf16 v[100:115], v[56:59], v[164:167], v[100:115]
    ds_read_b64_tr_b16 v[80:81], v10 offset:31744
    ds_read_b64_tr_b16 v[82:83], v10 offset:32000
    s_waitcnt lgkmcnt(10)
    v_mfma_f32_32x32x16_bf16 v[20:35], v[60:63], v[168:171], v[20:35]
    ds_read_b64_tr_b16 v[52:53], v10 offset:32768
    ds_read_b64_tr_b16 v[54:55], v10 offset:33024
    s_waitcnt lgkmcnt(10)
    v_mfma_f32_32x32x16_bf16 v[100:115], v[64:67], v[172:175], v[100:115]
    ds_read_b64_tr_b16 v[56:57], v10 offset:33792
    ds_read_b64_tr_b16 v[58:59], v10 offset:34048
    s_waitcnt lgkmcnt(10)
    v_mfma_f32_32x32x16_bf16 v[20:35], v[68:71], v[176:179], v[20:35]
    ds_read_b64_tr_b16 v[60:61], v10 offset:34816
    ds_read_b64_tr_b16 v[62:63], v10 offset:35072
    s_waitcnt lgkmcnt(10)
    v_mfma_f32_32x32x16_bf16 v[100:115], v[72:75], v[180:183], v[100:115]
    ds_read_b64_tr_b16 v[64:65], v10 offset:35840
    ds_read_b64_tr_b16 v[66:67], v10 offset:36096
    s_waitcnt lgkmcnt(10)
    v_mfma_f32_32x32x16_bf16 v[20:35], v[76:79], v[184:187], v[20:35]
    ds_read_b64_tr_b16 v[68:69], v10 offset:36864
    ds_read_b64_tr_b16 v[70:71], v10 offset:37120
    s_waitcnt lgkmcnt(10)
    v_mfma_f32_32x32x16_bf16 v[100:115], v[80:83], v[188:191], v[100:115]
    ds_read_b64_tr_b16 v[72:73], v10 offset:37888
    ds_read_b64_tr_b16 v[74:75], v10 offset:38144
    s_waitcnt lgkmcnt(10)
    v_mfma_f32_32x32x16_bf16 v[20:35], v[52:55], v[192:195], v[20:35]
    ds_read_b64_tr_b16 v[76:77], v10 offset:38912
    ds_read_b64_tr_b16 v[78:79], v10 offset:39168
    s_waitcnt lgkmcnt(10)
    v_mfma_f32_32x32x16_bf16 v[100:115], v[56:59], v[196:199], v[100:115]
    ds_read_b64_tr_b16 v[80:81], v10 offset:39936
    ds_read_b64_tr_b16 v[82:83], v10 offset:40192
    s_waitcnt lgkmcnt(10)
    v_mfma_f32_32x32x16_bf16 v[20:35], v[60:63], v[200:203], v[20:35]
    ds_read_b64_tr_b16 v[52:53], v9 offset:0
    ds_read_b64_tr_b16 v[54:55], v9 offset:256
    s_waitcnt lgkmcnt(10)
    v_mfma_f32_32x32x16_bf16 v[100:115], v[64:67], v[204:207], v[100:115]
    ds_read_b64_tr_b16 v[56:57], v9 offset:1024
    ds_read_b64_tr_b16 v[58:59], v9 offset:1280
    s_waitcnt lgkmcnt(10)
    v_mfma_f32_32x32x16_bf16 v[20:35], v[68:71], v[208:211], v[20:35]
    ds_read_b64_tr_b16 v[60:61], v9 offset:2048
    ds_read_b64_tr_b16 v[62:63], v9 offset:2304
    s_waitcnt lgkmcnt(10)
    v_mfma_f32_32x32x16_bf16 v[100:115], v[72:75], v[212:215], v[100:115]
    ds_read_b64_tr_b16 v[64:65], v9 offset:3072
    ds_read_b64_tr_b16 v[66:67], v9 offset:3328
    s_waitcnt lgkmcnt(10)
    v_mfma_f32_32x32x16_bf16 v[20:35], v[76:79], v[216:219], v[20:35]
    ds_read_b64_tr_b16 v[68:69], v9 offset:4096
    ds_read_b64_tr_b16 v[70:71], v9 offset:4352
    s_waitcnt lgkmcnt(10)
    v_mfma_f32_32x32x16_bf16 v[100:115], v[80:83], v[220:223], v[100:115]
    ds_read_b64_tr_b16 v[72:73], v9 offset:5120
    ds_read_b64_tr_b16 v[74:75], v9 offset:5376
    s_waitcnt lgkmcnt(10)
    v_mfma_f32_32x32x16_bf16 v[20:35], v[52:55], v[224:227], v[20:35]
    ds_read_b64_tr_b16 v[76:77], v9 offset:6144
    ds_read_b64_tr_b16 v[78:79], v9 offset:6400
    s_waitcnt lgkmcnt(10)
    v_mfma_f32_32x32x16_bf16 v[100:115], v[56:59], v[228:231], v[100:115]
    ds_read_b64_tr_b16 v[80:81], v9 offset:7168
    ds_read_b64_tr_b16 v[82:83], v9 offset:7424
    s_waitcnt lgkmcnt(10)
    v_mfma_f32_32x32x16_bf16 v[20:35], v[60:63], v[232:235], v[20:35]
    s_waitcnt lgkmcnt(8)
    v_mfma_f32_32x32x16_bf16 v[100:115], v[64:67], v[236:239], v[100:115]
    s_waitcnt lgkmcnt(6)
    v_mfma_f32_32x32x16_bf16 v[20:35], v[68:71], v[240:243], v[20:35]
    s_waitcnt lgkmcnt(4)
    v_mfma_f32_32x32x16_bf16 v[100:115], v[72:75], v[244:247], v[100:115]
    s_waitcnt lgkmcnt(2)
    v_mfma_f32_32x32x16_bf16 v[20:35], v[76:79], v[248:251], v[20:35]
    s_waitcnt lgkmcnt(0)
    v_mfma_f32_32x32x16_bf16 v[100:115], v[80:83], v[252:255], v[100:115]
    s_mov_b32 s56, s22
    s_mov_b32 s57, s23
    s_mov_b32 s58, 0x80000
    s_mov_b32 s59, 0x20000
    s_lshl_b32 s32, s31, 2
    s_add_u32 s32, s32, s10
    v_lshrrev_b32 v2, 4, v1
    v_bfe_u32 v3, v1, 2, 2
    v_xor_b32 v3, v3, v2
    v_lshlrev_b32 v3, 6, v3
    v_lshl_add_u32 v2, v2, 10, v3
    v_and_b32 v3, 3, v1
    v_lshl_add_u32 v2, v3, 4, v2
    s_lshl_b32 s11, s31, 8
    s_lshl_b32 s12, s10, 16
    s_add_u32 s11, s11, s12
    v_add_u32 v2, s11, v2
    s_lshl_b32 s14, s10, 14
    s_lshl_b32 s12, s7, 2
    s_add_u32 s12, s12, s10
    s_lshl_b32 s12, s12, 5
    s_add_u32 s12, s12, s34
    s_lshl_b32 s12, s12, 10
    s_add_u32 s37, s12, 4194304
    v_lshlrev_b32 v4, 4, v1
    s_lshl_b32 s24, s8, 8
    s_add_u32 s24, s24, 8609792
    s_lshl_b32 s33, s7, 2
    s_add_u32 s33, s33, s10
    s_lshl_b32 s33, s33, 7
    s_add_u32 s33, s33, 8601600
    v_pk_add_f32 v[20:21], v[20:21], v[100:101]
    v_pk_add_f32 v[22:23], v[22:23], v[102:103]
    v_pk_add_f32 v[24:25], v[24:25], v[104:105]
    v_pk_add_f32 v[26:27], v[26:27], v[106:107]
    v_pk_add_f32 v[28:29], v[28:29], v[108:109]
    v_pk_add_f32 v[30:31], v[30:31], v[110:111]
    v_pk_add_f32 v[32:33], v[32:33], v[112:113]
    v_pk_add_f32 v[34:35], v[34:35], v[114:115]
    v_cvt_pk_bf16_f32 v52, v20, v21
    v_cvt_pk_bf16_f32 v53, v22, v23
    v_cvt_pk_bf16_f32 v54, v24, v25
    v_cvt_pk_bf16_f32 v55, v26, v27
    v_cvt_pk_bf16_f32 v56, v28, v29
    v_cvt_pk_bf16_f32 v57, v30, v31
    v_cvt_pk_bf16_f32 v58, v32, v33
    v_cvt_pk_bf16_f32 v59, v34, v35
    v_mfma_f32_32x32x16_bf16 v[84:99], v[12:15], v[52:55], 0
    s_nop 0
    v_mfma_f32_32x32x16_bf16 v[100:115], v[16:19], v[56:59], 0
    s_waitcnt vmcnt(0)
    s_barrier
    s_cmp_eq_u32 s10, 1
    s_cbranch_scc0 G_B1
    v_mov_b32 v10, 0
    v_mov_b32 v11, 1
    s_mov_b64 exec, 1
    buffer_atomic_add v11, v10, s[60:63], s24 offen sc1
    s_mov_b64 exec, -1
G_B1:
    s_add_u32 m0, s14, 0
    s_mov_b32 s11, 0
    buffer_load_dwordx4 v2, s[56:59], s11 offen offset:0 lds
    s_add_u32 m0, s14, 0
    s_mov_b32 s11, 3072
    buffer_load_dwordx4 v2, s[56:59], s11 offen offset:1024 lds
    s_add_u32 m0, s14, 0
    s_mov_b32 s11, 6144
    buffer_load_dwordx4 v2, s[56:59], s11 offen offset:2048 lds
    s_add_u32 m0, s14, 0
    s_mov_b32 s11, 9216
    buffer_load_dwordx4 v2, s[56:59], s11 offen offset:3072 lds
    s_add_u32 m0, s14, 4096
    s_mov_b32 s11, 16384
    buffer_load_dwordx4 v2, s[56:59], s11 offen offset:0 lds
    s_add_u32 m0, s14, 4096
    s_mov_b32 s11, 19456
    buffer_load_dwordx4 v2, s[56:59], s11 offen offset:1024 lds
    s_add_u32 m0, s14, 4096
    s_mov_b32 s11, 22528
    buffer_load_dwordx4 v2, s[56:59], s11 offen offset:2048 lds
    s_add_u32 m0, s14, 4096
    s_mov_b32 s11, 25600
    buffer_load_dwordx4 v2, s[56:59], s11 offen offset:3072 lds
    v_max3_f32 v118, v84, v85, v86
    v_max3_f32 v36, v100, v101, v102
    v_max3_f32 v119, v87, v88, v89
    v_max3_f32 v37, v103, v104, v105
    v_max3_f32 v118, v118, v90, v91
    v_max3_f32 v36, v36, v106, v107
    v_max3_f32 v119, v119, v92, v93
    v_max3_f32 v37, v37, v108, v109
    v_max3_f32 v118, v118, v94, v95
    v_max3_f32 v36, v36, v110, v111
    v_max3_f32 v119, v119, v96, v97
    v_max3_f32 v37, v37, v112, v113
    v_max3_f32 v118, v118, v98, v99
    v_max3_f32 v36, v36, v114, v115
    v_max_f32 v118, v118, v119
    v_max_f32 v36, v36, v37
    v_mul_f32 v118, v116, v118
    v_mul_f32 v36, v116, v36
    v_pk_fma_f32 v[84:85], v[84:85], v[116:117], v[118:119] op_sel_hi:[1,0,0] neg_lo:[0,0,1] neg_hi:[0,0,1]
    v_pk_fma_f32 v[100:101], v[100:101], v[116:117], v[36:37] op_sel_hi:[1,0,0] neg_lo:[0,0,1] neg_hi:[0,0,1]
    v_pk_fma_f32 v[86:87], v[86:87], v[116:117], v[118:119] op_sel_hi:[1,0,0] neg_lo:[0,0,1] neg_hi:[0,0,1]
    v_pk_fma_f32 v[102:103], v[102:103], v[116:117], v[36:37] op_sel_hi:[1,0,0] neg_lo:[0,0,1] neg_hi:[0,0,1]
    v_pk_fma_f32 v[88:89], v[88:89], v[116:117], v[118:119] op_sel_hi:[1,0,0] neg_lo:[0,0,1] neg_hi:[0,0,1]
    v_pk_fma_f32 v[104:105], v[104:105], v[116:117], v[36:37] op_sel_hi:[1,0,0] neg_lo:[0,0,1] neg_hi:[0,0,1]
    v_pk_fma_f32 v[90:91], v[90:91], v[116:117], v[118:119] op_sel_hi:[1,0,0] neg_lo:[0,0,1] neg_hi:[0,0,1]
    v_pk_fma_f32 v[106:107], v[106:107], v[116:117], v[36:37] op_sel_hi:[1,0,0] neg_lo:[0,0,1] neg_hi:[0,0,1]
    v_pk_fma_f32 v[92:93], v[92:93], v[116:117], v[118:119] op_sel_hi:[1,0,0] neg_lo:[0,0,1] neg_hi:[0,0,1]
    v_pk_fma_f32 v[108:109], v[108:109], v[116:117], v[36:37] op_sel_hi:[1,0,0] neg_lo:[0,0,1] neg_hi:[0,0,1]
    v_pk_fma_f32 v[94:95], v[94:95], v[116:117], v[118:119] op_sel_hi:[1,0,0] neg_lo:[0,0,1] neg_hi:[0,0,1]
    v_pk_fma_f32 v[110:111], v[110:111], v[116:117], v[36:37] op_sel_hi:[1,0,0] neg_lo:[0,0,1] neg_hi:[0,0,1]
    v_pk_fma_f32 v[96:97], v[96:97], v[116:117], v[118:119] op_sel_hi:[1,0,0] neg_lo:[0,0,1] neg_hi:[0,0,1]
    v_pk_fma_f32 v[112:113], v[112:113], v[116:117], v[36:37] op_sel_hi:[1,0,0] neg_lo:[0,0,1] neg_hi:[0,0,1]
    v_pk_fma_f32 v[98:99], v[98:99], v[116:117], v[118:119] op_sel_hi:[1,0,0] neg_lo:[0,0,1] neg_hi:[0,0,1]
    v_pk_fma_f32 v[114:115], v[114:115], v[116:117], v[36:37] op_sel_hi:[1,0,0] neg_lo:[0,0,1] neg_hi:[0,0,1]
    v_exp_f32 v84, v84
    v_exp_f32 v100, v100
    v_exp_f32 v85, v85
    v_exp_f32 v101, v101
    v_exp_f32 v86, v86
    v_exp_f32 v102, v102
    v_exp_f32 v87, v87
    v_exp_f32 v103, v103
    v_exp_f32 v88, v88
    v_exp_f32 v104, v104
    v_exp_f32 v89, v89
    v_exp_f32 v105, v105
    v_exp_f32 v90, v90
    v_exp_f32 v106, v106
    v_exp_f32 v91, v91
    v_exp_f32 v107, v107
    v_exp_f32 v92, v92
    v_exp_f32 v108, v108
    v_exp_f32 v93, v93
    v_exp_f32 v109, v109
    v_exp_f32 v94, v94
    v_exp_f32 v110, v110
    v_exp_f32 v95, v95
    v_exp_f32 v111, v111
    v_exp_f32 v96, v96
    v_exp_f32 v112, v112
    v_exp_f32 v97, v97
    v_exp_f32 v113, v113
    v_exp_f32 v98, v98
    v_exp_f32 v114, v114
    v_exp_f32 v99, v99
    v_exp_f32 v115, v115
    v_pk_add_f32 v[120:121], v[84:85], v[86:87]
    v_pk_add_f32 v[38:39], v[100:101], v[102:103]
    v_pk_add_f32 v[122:123], v[88:89], v[90:91]
    v_pk_add_f32 v[40:41], v[104:105], v[106:107]
    s_cmp_eq_u32 s10, 0
    s_cbranch_scc0 G_PK0
    s_load_dword s38, s[48:49], s24 glc
G_PK0:
    v_pk_add_f32 v[120:121], v[120:121], v[92:93]
    v_pk_add_f32 v[38:39], v[38:39], v[108:109]
    v_pk_add_f32 v[122:123], v[122:123], v[94:95]
    v_pk_add_f32 v[40:41], v[40:41], v[110:111]
    v_pk_add_f32 v[120:121], v[120:121], v[96:97]
    v_pk_add_f32 v[38:39], v[38:39], v[112:113]
    v_pk_add_f32 v[122:123], v[122:123], v[98:99]
    v_pk_add_f32 v[40:41], v[40:41], v[114:115]
    v_pk_add_f32 v[120:121], v[120:121], v[122:123]
    v_pk_add_f32 v[38:39], v[38:39], v[40:41]
    v_add_f32 v120, v120, v121
    v_add_f32 v38, v38, v39
    v_rcp_f32 v120, v120
    v_rcp_f32 v38, v38
    v_pk_mul_f32 v[84:85], v[84:85], v[120:121] op_sel_hi:[1,0]
    v_pk_mul_f32 v[100:101], v[100:101], v[38:39] op_sel_hi:[1,0]
    v_pk_mul_f32 v[86:87], v[86:87], v[120:121] op_sel_hi:[1,0]
    v_pk_mul_f32 v[102:103], v[102:103], v[38:39] op_sel_hi:[1,0]
    v_pk_mul_f32 v[88:89], v[88:89], v[120:121] op_sel_hi:[1,0]
    v_pk_mul_f32 v[104:105], v[104:105], v[38:39] op_sel_hi:[1,0]
    v_pk_mul_f32 v[90:91], v[90:91], v[120:121] op_sel_hi:[1,0]
    v_pk_mul_f32 v[106:107], v[106:107], v[38:39] op_sel_hi:[1,0]
    v_pk_mul_f32 v[92:93], v[92:93], v[120:121] op_sel_hi:[1,0]
    v_pk_mul_f32 v[108:109], v[108:109], v[38:39] op_sel_hi:[1,0]
    v_pk_mul_f32 v[94:95], v[94:95], v[120:121] op_sel_hi:[1,0]
    v_pk_mul_f32 v[110:111], v[110:111], v[38:39] op_sel_hi:[1,0]
    v_pk_mul_f32 v[96:97], v[96:97], v[120:121] op_sel_hi:[1,0]
    v_pk_mul_f32 v[112:113], v[112:113], v[38:39] op_sel_hi:[1,0]
    v_pk_mul_f32 v[98:99], v[98:99], v[120:121] op_sel_hi:[1,0]
    v_pk_mul_f32 v[114:115], v[114:115], v[38:39] op_sel_hi:[1,0]
    v_cvt_pk_bf16_f32 v68, v84, v85
    v_cvt_pk_bf16_f32 v76, v100, v101
    v_cvt_pk_bf16_f32 v69, v86, v87
    v_cvt_pk_bf16_f32 v77, v102, v103
    v_cvt_pk_bf16_f32 v70, v88, v89
    v_cvt_pk_bf16_f32 v78, v104, v105
    v_cvt_pk_bf16_f32 v71, v90, v91
    v_cvt_pk_bf16_f32 v79, v106, v107
    v_cvt_pk_bf16_f32 v72, v92, v93
    v_cvt_pk_bf16_f32 v80, v108, v109
    v_cvt_pk_bf16_f32 v73, v94, v95
    v_cvt_pk_bf16_f32 v81, v110, v111
    v_cvt_pk_bf16_f32 v74, v96, v97
    v_cvt_pk_bf16_f32 v82, v112, v113
    v_cvt_pk_bf16_f32 v75, v98, v99
    v_cvt_pk_bf16_f32 v83, v114, v115
    s_add_u32 m0, s14, 8192
    s_mov_b32 s11, 32768
    buffer_load_dwordx4 v2, s[56:59], s11 offen offset:0 lds
    s_add_u32 m0, s14, 8192
    s_mov_b32 s11, 35840
    buffer_load_dwordx4 v2, s[56:59], s11 offen offset:1024 lds
    s_add_u32 m0, s14, 8192
    s_mov_b32 s11, 38912
    buffer_load_dwordx4 v2, s[56:59], s11 offen offset:2048 lds
    s_add_u32 m0, s14, 8192
    s_mov_b32 s11, 41984
    buffer_load_dwordx4 v2, s[56:59], s11 offen offset:3072 lds
    s_add_u32 m0, s14, 12288
    s_mov_b32 s11, 49152
    buffer_load_dwordx4 v2, s[56:59], s11 offen offset:0 lds
    s_add_u32 m0, s14, 12288
    s_mov_b32 s11, 52224
    buffer_load_dwordx4 v2, s[56:59], s11 offen offset:1024 lds
    s_add_u32 m0, s14, 12288
    s_mov_b32 s11, 55296
    buffer_load_dwordx4 v2, s[56:59], s11 offen offset:2048 lds
    s_add_u32 m0, s14, 12288
    s_mov_b32 s11, 58368
    buffer_load_dwordx4 v2, s[56:59], s11 offen offset:3072 lds
    v_bfe_u32 v10, v1, 2, 2
    v_lshrrev_b32 v12, 5, v1
    v_lshl_add_u32 v11, v12, 2, v10
    v_lshlrev_b32 v11, 8, v11
    v_xor_b32 v10, s10, v10
    v_lshl_add_u32 v11, v10, 6, v11
    v_bfe_u32 v10, v1, 4, 1
    v_lshl_add_u32 v11, v10, 5, v11
    v_and_b32 v10, 3, v1
    v_lshl_add_u32 v9, v10, 3, v11
    v_and_b32 v10, 31, v1
    v_lshlrev_b32 v5, 14, v12
    v_lshl_add_u32 v5, v10, 1, v5
    v_lshlrev_b32 v13, 10, v10
    v_lshl_add_u32 v13, v12, 4, v13
    v_lshlrev_b32 v15, 2, v10
    v_min_u32 v10, 16, v10
    v_bfe_u32 v11, v10, 1, 2
    v_lshlrev_b32 v12, 1, v12
    v_xor_b32 v11, v11, v12
    v_lshlrev_b32 v11, 4, v11
    v_lshl_add_u32 v10, v10, 6, v11
    v_add_u32 v6, 65536, v10
    v_xor_b32 v7, 16, v6
    v_lshrrev_b32 v10, 3, v1
    v_and_b32 v11, 7, v1
    v_mul_u32_u24 v3, 1088, v10
    v_lshl_add_u32 v3, v11, 3, v3
    v_add_u32 v3, 66560, v3
    v_and_b32 v12, 6, v10
    v_xor_b32 v11, v11, v12
    v_lshlrev_b32 v11, 3, v11
    v_lshl_add_u32 v14, v10, 6, v11
    s_lshr_b32 s11, s10, 1
    s_mul_i32 s11, s11, 1088
    s_and_b32 s12, s10, 1
    s_lshl_b32 s12, s12, 9
    s_add_u32 s11, s11, s12
    s_add_u32 s11, s11, 65536
    v_add_u32 v14, s11, v14
    s_cmp_eq_u32 s10, 0
    s_cbranch_scc0 G_PKB
    s_mov_b32 s51, 0
    s_branch G_PKC
G_PKP:
    s_load_dword s38, s[48:49], s24 glc
G_PKC:
    s_waitcnt lgkmcnt(0)
    s_cmp_lg_u32 s38, 16
    s_cbranch_scc1 G_PKR
    s_branch G_PKB
G_PKR:
    s_add_u32 s51, s51, 1
    s_cmp_gt_u32 s51, 100000
    s_cbranch_scc1 G_PKB
    s_sleep 3
    s_branch G_PKP
G_PKB:
    s_waitcnt vmcnt(0)
    s_barrier
    buffer_load_dwordx4 v[20:23], v4, s[60:63], s35 offen sc1
    s_mov_b64 exec, 0xffff
    buffer_load_dwordx4 v[24:27], v4, s[60:63], s36 offen sc1
    s_mov_b64 exec, -1
    ds_read_b64_tr_b16 v[128:129], v9 offset:0
    ds_read_b64_tr_b16 v[130:131], v9 offset:2048
    ds_read_b64_tr_b16 v[132:133], v9 offset:4096
    ds_read_b64_tr_b16 v[134:135], v9 offset:6144
    ds_read_b64_tr_b16 v[136:137], v9 offset:8192
    ds_read_b64_tr_b16 v[138:139], v9 offset:10240
    ds_read_b64_tr_b16 v[140:141], v9 offset:12288
    ds_read_b64_tr_b16 v[142:143], v9 offset:14336
    ds_read_b64_tr_b16 v[144:145], v9 offset:16384
    ds_read_b64_tr_b16 v[146:147], v9 offset:18432
    ds_read_b64_tr_b16 v[148:149], v9 offset:20480
    ds_read_b64_tr_b16 v[150:151], v9 offset:22528
    ds_read_b64_tr_b16 v[152:153], v9 offset:24576
    ds_read_b64_tr_b16 v[154:155], v9 offset:26624
    ds_read_b64_tr_b16 v[156:157], v9 offset:28672
    ds_read_b64_tr_b16 v[158:159], v9 offset:30720
    ds_read_b64_tr_b16 v[160:161], v9 offset:32768
    ds_read_b64_tr_b16 v[162:163], v9 offset:34816
    ds_read_b64_tr_b16 v[164:165], v9 offset:36864
    ds_read_b64_tr_b16 v[166:167], v9 offset:38912
    ds_read_b64_tr_b16 v[168:169], v9 offset:40960
    ds_read_b64_tr_b16 v[170:171], v9 offset:43008
    ds_read_b64_tr_b16 v[172:173], v9 offset:45056
    ds_read_b64_tr_b16 v[174:175], v9 offset:47104
    ds_read_b64_tr_b16 v[176:177], v9 offset:49152
    ds_read_b64_tr_b16 v[178:179], v9 offset:51200
    ds_read_b64_tr_b16 v[180:181], v9 offset:53248
    ds_read_b64_tr_b16 v[182:183], v9 offset:55296
    ds_read_b64_tr_b16 v[184:185], v9 offset:57344
    ds_read_b64_tr_b16 v[186:187], v9 offset:59392
    ds_read_b64_tr_b16 v[188:189], v9 offset:61440
    ds_read_b64_tr_b16 v[190:191], v9 offset:63488
    s_mov_b32 s20, s44
    s_mov_b32 s21, s45
    s_mov_b32 s22, 0x200000
    s_mov_b32 s23, 0x20000
    s_lshl_b32 s35, s30, 15
    s_lshl_b32 s11, s10, 13
    s_add_u32 s34, s35, s11
    s_add_u32 s34, s34, 4194304
    s_lshl_b32 s36, s32, 17
    s_lshl_b32 s11, s30, 6
    s_add_u32 s36, s36, s11
    s_add_u32 s36, s36, 2097152
    s_lshl_b32 s11, s32, 6
    s_add_u32 s15, s35, s11
    s_lshl_b32 s24, s30, 7
    s_add_u32 s24, s24, 8613888
    s_waitcnt vmcnt(1)
    v_cvt_pk_bf16_f32 v28, v20, v21
    v_cvt_pk_bf16_f32 v29, v22, v23
    ds_write_b64 v14, v[28:29]
    s_waitcnt vmcnt(0)
    v_cvt_pk_bf16_f32 v30, v24, v25
    v_cvt_pk_bf16_f32 v31, v26, v27
    s_mov_b64 exec, 0xffff
    ds_write_b64 v3, v[30:31]
    s_mov_b64 exec, -1
    s_waitcnt lgkmcnt(0)
    s_barrier
    ds_read_b128 v[20:23], v6 offset:0
    ds_read_b128 v[24:27], v7 offset:0
    ds_read_b128 v[28:31], v6 offset:1088
    ds_read_b128 v[32:35], v7 offset:1088
    s_add_u32 m0, s14, 0
    s_mov_b32 s11, 262144
    buffer_load_dwordx4 v2, s[56:59], s11 offen offset:0 lds
    s_add_u32 m0, s14, 0
    s_mov_b32 s11, 265216
    buffer_load_dwordx4 v2, s[56:59], s11 offen offset:1024 lds
    s_add_u32 m0, s14, 0
    s_mov_b32 s11, 268288
    buffer_load_dwordx4 v2, s[56:59], s11 offen offset:2048 lds
    s_add_u32 m0, s14, 0
    s_mov_b32 s11, 271360
    buffer_load_dwordx4 v2, s[56:59], s11 offen offset:3072 lds
    s_add_u32 m0, s14, 4096
    s_mov_b32 s11, 278528
    buffer_load_dwordx4 v2, s[56:59], s11 offen offset:0 lds
    s_add_u32 m0, s14, 4096
    s_mov_b32 s11, 281600
    buffer_load_dwordx4 v2, s[56:59], s11 offen offset:1024 lds
    s_waitcnt lgkmcnt(2)
    v_mfma_f32_32x32x16_bf16 v[36:51], v[20:23], v[68:71], 0
    v_mfma_f32_32x32x16_bf16 v[36:51], v[24:27], v[72:75], v[36:51]
    s_waitcnt lgkmcnt(0)
    v_mfma_f32_32x32x16_bf16 v[52:67], v[28:31], v[76:79], 0
    v_mfma_f32_32x32x16_bf16 v[52:67], v[32:35], v[80:83], v[52:67]
    s_nop 8
    v_add_f32 v44, 0x358637bd, v44
    v_rcp_f32 v44, v44
    s_nop 0
    v_pk_mul_f32 v[36:37], v[36:37], v[44:45] op_sel_hi:[1,0]
    v_pk_mul_f32 v[38:39], v[38:39], v[44:45] op_sel_hi:[1,0]
    v_pk_mul_f32 v[40:41], v[40:41], v[44:45] op_sel_hi:[1,0]
    v_pk_mul_f32 v[42:43], v[42:43], v[44:45] op_sel_hi:[1,0]
    v_cvt_pk_bf16_f32 v48, v36, v37
    v_cvt_pk_bf16_f32 v49, v38, v39
    v_cvt_pk_bf16_f32 v50, v40, v41
    v_cvt_pk_bf16_f32 v51, v42, v43
    buffer_store_dwordx4 v[48:51], v4, s[60:63], s37 offen offset:0 sc1
    v_add_f32 v60, 0x358637bd, v60
    v_rcp_f32 v60, v60
    s_nop 0
    v_pk_mul_f32 v[52:53], v[52:53], v[60:61] op_sel_hi:[1,0]
    v_pk_mul_f32 v[54:55], v[54:55], v[60:61] op_sel_hi:[1,0]
    v_pk_mul_f32 v[56:57], v[56:57], v[60:61] op_sel_hi:[1,0]
    v_pk_mul_f32 v[58:59], v[58:59], v[60:61] op_sel_hi:[1,0]
    v_cvt_pk_bf16_f32 v64, v52, v53
    v_cvt_pk_bf16_f32 v65, v54, v55
    v_cvt_pk_bf16_f32 v66, v56, v57
    v_cvt_pk_bf16_f32 v67, v58, v59
    buffer_store_dwordx4 v[64:67], v4, s[60:63], s37 offen offset:1024 sc1
    s_add_u32 m0, s14, 4096
    s_mov_b32 s11, 284672
    buffer_load_dwordx4 v2, s[56:59], s11 offen offset:2048 lds
    s_add_u32 m0, s14, 4096
    s_mov_b32 s11, 287744
    buffer_load_dwordx4 v2, s[56:59], s11 offen offset:3072 lds
    s_add_u32 m0, s14, 8192
    s_mov_b32 s11, 294912
    buffer_load_dwordx4 v2, s[56:59], s11 offen offset:0 lds
    s_add_u32 m0, s14, 8192
    s_mov_b32 s11, 297984
    buffer_load_dwordx4 v2, s[56:59], s11 offen offset:1024 lds
    s_add_u32 m0, s14, 8192
    s_mov_b32 s11, 301056
    buffer_load_dwordx4 v2, s[56:59], s11 offen offset:2048 lds
    s_add_u32 m0, s14, 8192
    s_mov_b32 s11, 304128
    buffer_load_dwordx4 v2, s[56:59], s11 offen offset:3072 lds
    s_add_u32 m0, s14, 12288
    s_mov_b32 s11, 311296
    buffer_load_dwordx4 v2, s[56:59], s11 offen offset:0 lds
    s_add_u32 m0, s14, 12288
    s_mov_b32 s11, 314368
    buffer_load_dwordx4 v2, s[56:59], s11 offen offset:1024 lds
    s_add_u32 m0, s14, 12288
    s_mov_b32 s11, 317440
    buffer_load_dwordx4 v2, s[56:59], s11 offen offset:2048 lds
    s_add_u32 m0, s14, 12288
    s_mov_b32 s11, 320512
    buffer_load_dwordx4 v2, s[56:59], s11 offen offset:3072 lds
    s_lshl_b32 s40, s30, 7
    s_add_u32 s40, s40, 8601600
    s_lshl_b32 s41, s31, 9
    s_add_u32 s41, s41, s25
    s_add_u32 s42, s41, 256
    s_lshr_b32 s43, s30, 3
    s_lshl_b32 s43, s43, 8
    s_add_u32 s43, s43, s25
    v_mov_b32 v10, 0
    v_mov_b32 v11, 1
    s_waitcnt vmcnt(10)
    s_mov_b64 exec, 1
    buffer_atomic_add v11, v10, s[60:63], s33 offen sc1
    s_mov_b64 exec, -1
    s_waitcnt vmcnt(1)
    s_barrier
    ds_read_b64_tr_b16 v[192:193], v9 offset:0
    ds_read_b64_tr_b16 v[194:195], v9 offset:2048
    ds_read_b64_tr_b16 v[196:197], v9 offset:4096
    ds_read_b64_tr_b16 v[198:199], v9 offset:6144
    ds_read_b64_tr_b16 v[200:201], v9 offset:8192
    ds_read_b64_tr_b16 v[202:203], v9 offset:10240
    ds_read_b64_tr_b16 v[204:205], v9 offset:12288
    ds_read_b64_tr_b16 v[206:207], v9 offset:14336
    ds_read_b64_tr_b16 v[208:209], v9 offset:16384
    ds_read_b64_tr_b16 v[210:211], v9 offset:18432
    ds_read_b64_tr_b16 v[212:213], v9 offset:20480
    ds_read_b64_tr_b16 v[214:215], v9 offset:22528
    ds_read_b64_tr_b16 v[216:217], v9 offset:24576
    ds_read_b64_tr_b16 v[218:219], v9 offset:26624
    ds_read_b64_tr_b16 v[220:221], v9 offset:28672
    ds_read_b64_tr_b16 v[222:223], v9 offset:30720
    ds_read_b64_tr_b16 v[224:225], v9 offset:32768
    ds_read_b64_tr_b16 v[226:227], v9 offset:34816
    ds_read_b64_tr_b16 v[228:229], v9 offset:36864
    ds_read_b64_tr_b16 v[230:231], v9 offset:38912
    ds_read_b64_tr_b16 v[232:233], v9 offset:40960
    ds_read_b64_tr_b16 v[234:235], v9 offset:43008
    ds_read_b64_tr_b16 v[236:237], v9 offset:45056
    ds_read_b64_tr_b16 v[238:239], v9 offset:47104
    ds_read_b64_tr_b16 v[240:241], v9 offset:49152
    ds_read_b64_tr_b16 v[242:243], v9 offset:51200
    ds_read_b64_tr_b16 v[244:245], v9 offset:53248
    ds_read_b64_tr_b16 v[246:247], v9 offset:55296
    ds_read_b64_tr_b16 v[248:249], v9 offset:57344
    ds_read_b64_tr_b16 v[250:251], v9 offset:59392
    ds_read_b64_tr_b16 v[252:253], v9 offset:61440
    ds_read_b64_tr_b16 v[254:255], v9 offset:63488
    s_cmp_eq_u32 s10, 0
    s_cbranch_scc0 G_POB
    v_mov_b32 v12, 32
    v_writelane_b32 v10, s40, 0
    v_writelane_b32 v10, s41, 1
    v_writelane_b32 v10, s42, 2
    v_writelane_b32 v10, s43, 3
    v_writelane_b32 v12, 16, 0
    s_mov_b32 s51, 0
    s_mov_b64 exec, 15
G_POP:
    buffer_load_dword v11, v10, s[60:63], 0 offen sc1
    s_waitcnt vmcnt(0)
    v_cmp_ne_u32 vcc, v12, v11
    s_nop 1
    s_cbranch_vccz G_POK
    s_add_u32 s51, s51, 1
    s_cmp_gt_u32 s51, 100000
    s_cbranch_scc1 G_POK
    s_sleep 2
    s_branch G_POP
G_POK:
    s_mov_b64 exec, -1
G_POB:
    s_waitcnt lgkmcnt(0)
    s_barrier
    s_lshl_b32 s11, s10, 13
    s_add_u32 m0, s11, 0
    s_add_u32 s12, s34, 0
    buffer_load_dwordx4 v4, s[60:63], s12 offen offset:0 sc1 lds
    buffer_load_dwordx4 v4, s[60:63], s12 offen offset:1024 sc1 lds
    buffer_load_dwordx4 v4, s[60:63], s12 offen offset:2048 sc1 lds
    buffer_load_dwordx4 v4, s[60:63], s12 offen offset:3072 sc1 lds
    s_lshl_b32 s11, s10, 13
    s_add_u32 m0, s11, 4096
    s_add_u32 s12, s34, 4096
    buffer_load_dwordx4 v4, s[60:63], s12 offen offset:0 sc1 lds
    buffer_load_dwordx4 v4, s[60:63], s12 offen offset:1024 sc1 lds
    buffer_load_dwordx4 v4, s[60:63], s12 offen offset:2048 sc1 lds
    buffer_load_dwordx4 v4, s[60:63], s12 offen offset:3072 sc1 lds
    s_add_u32 s11, s36, 0
    buffer_load_ushort v64, v5, s[60:63], s11 offen sc1
    s_add_u32 s11, s36, 4096
    buffer_load_ushort v65, v5, s[60:63], s11 offen sc1
    s_add_u32 s11, s36, 8192
    buffer_load_ushort v66, v5, s[60:63], s11 offen sc1
    s_add_u32 s11, s36, 12288
    buffer_load_ushort v67, v5, s[60:63], s11 offen sc1
    s_add_u32 s11, s36, 32768
    buffer_load_ushort v68, v5, s[60:63], s11 offen sc1
    s_add_u32 s11, s36, 36864
    buffer_load_ushort v69, v5, s[60:63], s11 offen sc1
    s_add_u32 s11, s36, 40960
    buffer_load_ushort v70, v5, s[60:63], s11 offen sc1
    s_add_u32 s11, s36, 45056
    buffer_load_ushort v71, v5, s[60:63], s11 offen sc1
    s_add_u32 s11, s36, 65536
    buffer_load_ushort v72, v5, s[60:63], s11 offen sc1
    s_add_u32 s11, s36, 69632
    buffer_load_ushort v73, v5, s[60:63], s11 offen sc1
    s_add_u32 s11, s36, 73728
    buffer_load_ushort v74, v5, s[60:63], s11 offen sc1
    s_add_u32 s11, s36, 77824
    buffer_load_ushort v75, v5, s[60:63], s11 offen sc1
    s_add_u32 s11, s36, 98304
    buffer_load_ushort v76, v5, s[60:63], s11 offen sc1
    s_add_u32 s11, s36, 102400
    buffer_load_ushort v77, v5, s[60:63], s11 offen sc1
    s_add_u32 s11, s36, 106496
    buffer_load_ushort v78, v5, s[60:63], s11 offen sc1
    s_add_u32 s11, s36, 110592
    buffer_load_ushort v79, v5, s[60:63], s11 offen sc1
    buffer_load_dword v15, v15, s[60:63], s24 offen sc1
    s_waitcnt vmcnt(17)
    s_barrier
    ds_read_b128 v[80:83], v4 offset:0
    ds_read_b128 v[84:87], v4 offset:1024
    ds_read_b128 v[88:91], v4 offset:2048
    ds_read_b128 v[92:95], v4 offset:3072
    ds_read_b128 v[96:99], v4 offset:4096
    ds_read_b128 v[100:103], v4 offset:5120
    ds_read_b128 v[104:107], v4 offset:6144
    ds_read_b128 v[108:111], v4 offset:7168
    s_waitcnt lgkmcnt(7)
    v_mfma_f32_32x32x16_bf16 v[36:51], v[128:131], v[80:83], 0
    ds_read_b128 v[80:83], v4 offset:8192
    s_waitcnt lgkmcnt(7)
    v_mfma_f32_32x32x16_bf16 v[36:51], v[132:135], v[84:87], v[36:51]
    ds_read_b128 v[84:87], v4 offset:9216
    s_waitcnt lgkmcnt(7)
    v_mfma_f32_32x32x16_bf16 v[36:51], v[136:139], v[88:91], v[36:51]
    ds_read_b128 v[88:91], v4 offset:10240
    s_waitcnt lgkmcnt(7)
    v_mfma_f32_32x32x16_bf16 v[36:51], v[140:143], v[92:95], v[36:51]
    ds_read_b128 v[92:95], v4 offset:11264
    s_waitcnt lgkmcnt(7)
    v_mfma_f32_32x32x16_bf16 v[36:51], v[144:147], v[96:99], v[36:51]
    ds_read_b128 v[96:99], v4 offset:12288
    s_waitcnt lgkmcnt(7)
    v_mfma_f32_32x32x16_bf16 v[36:51], v[148:151], v[100:103], v[36:51]
    ds_read_b128 v[100:103], v4 offset:13312
    s_waitcnt lgkmcnt(7)
    v_mfma_f32_32x32x16_bf16 v[36:51], v[152:155], v[104:107], v[36:51]
    ds_read_b128 v[104:107], v4 offset:14336
    s_waitcnt lgkmcnt(7)
    v_mfma_f32_32x32x16_bf16 v[36:51], v[156:159], v[108:111], v[36:51]
    ds_read_b128 v[108:111], v4 offset:15360
    s_waitcnt lgkmcnt(7)
    v_mfma_f32_32x32x16_bf16 v[36:51], v[160:163], v[80:83], v[36:51]
    ds_read_b128 v[80:83], v4 offset:16384
    s_waitcnt lgkmcnt(7)
    v_mfma_f32_32x32x16_bf16 v[36:51], v[164:167], v[84:87], v[36:51]
    ds_read_b128 v[84:87], v4 offset:17408
    s_waitcnt lgkmcnt(7)
    v_mfma_f32_32x32x16_bf16 v[36:51], v[168:171], v[88:91], v[36:51]
    ds_read_b128 v[88:91], v4 offset:18432
    s_waitcnt lgkmcnt(7)
    v_mfma_f32_32x32x16_bf16 v[36:51], v[172:175], v[92:95], v[36:51]
    ds_read_b128 v[92:95], v4 offset:19456
    s_waitcnt lgkmcnt(7)
    v_mfma_f32_32x32x16_bf16 v[36:51], v[176:179], v[96:99], v[36:51]
    ds_read_b128 v[96:99], v4 offset:20480
    s_waitcnt lgkmcnt(7)
    v_mfma_f32_32x32x16_bf16 v[36:51], v[180:183], v[100:103], v[36:51]
    ds_read_b128 v[100:103], v4 offset:21504
    s_waitcnt lgkmcnt(7)
    v_mfma_f32_32x32x16_bf16 v[36:51], v[184:187], v[104:107], v[36:51]
    ds_read_b128 v[104:107], v4 offset:22528
    s_waitcnt lgkmcnt(7)
    v_mfma_f32_32x32x16_bf16 v[36:51], v[188:191], v[108:111], v[36:51]
    ds_read_b128 v[108:111], v4 offset:23552
    s_waitcnt lgkmcnt(7)
    v_mfma_f32_32x32x16_bf16 v[36:51], v[192:195], v[80:83], v[36:51]
    ds_read_b128 v[80:83], v4 offset:24576
    s_waitcnt lgkmcnt(7)
    v_mfma_f32_32x32x16_bf16 v[36:51], v[196:199], v[84:87], v[36:51]
    ds_read_b128 v[84:87], v4 offset:25600
    s_waitcnt lgkmcnt(7)
    v_mfma_f32_32x32x16_bf16 v[36:51], v[200:203], v[88:91], v[36:51]
    ds_read_b128 v[88:91], v4 offset:26624
    s_waitcnt lgkmcnt(7)
    v_mfma_f32_32x32x16_bf16 v[36:51], v[204:207], v[92:95], v[36:51]
    ds_read_b128 v[92:95], v4 offset:27648
    s_waitcnt lgkmcnt(7)
    v_mfma_f32_32x32x16_bf16 v[36:51], v[208:211], v[96:99], v[36:51]
    ds_read_b128 v[96:99], v4 offset:28672
    s_waitcnt lgkmcnt(7)
    v_mfma_f32_32x32x16_bf16 v[36:51], v[212:215], v[100:103], v[36:51]
    ds_read_b128 v[100:103], v4 offset:29696
    s_waitcnt lgkmcnt(7)
    v_mfma_f32_32x32x16_bf16 v[36:51], v[216:219], v[104:107], v[36:51]
    ds_read_b128 v[104:107], v4 offset:30720
    s_waitcnt lgkmcnt(7)
    v_mfma_f32_32x32x16_bf16 v[36:51], v[220:223], v[108:111], v[36:51]
    ds_read_b128 v[108:111], v4 offset:31744
    s_waitcnt vmcnt(0)
    v_sub_f32 v12, 1.0, v15
    s_waitcnt lgkmcnt(7)
    v_mfma_f32_32x32x16_bf16 v[36:51], v[224:227], v[80:83], v[36:51]
    v_lshlrev_b32 v64, 16, v64
    v_mul_f32 v64, v12, v64
    v_lshlrev_b32 v65, 16, v65
    v_mul_f32 v65, v12, v65
    s_waitcnt lgkmcnt(6)
    v_mfma_f32_32x32x16_bf16 v[36:51], v[228:231], v[84:87], v[36:51]
    v_lshlrev_b32 v66, 16, v66
    v_mul_f32 v66, v12, v66
    v_lshlrev_b32 v67, 16, v67
    v_mul_f32 v67, v12, v67
    s_waitcnt lgkmcnt(5)
    v_mfma_f32_32x32x16_bf16 v[36:51], v[232:235], v[88:91], v[36:51]
    v_lshlrev_b32 v68, 16, v68
    v_mul_f32 v68, v12, v68
    v_lshlrev_b32 v69, 16, v69
    v_mul_f32 v69, v12, v69
    s_waitcnt lgkmcnt(4)
    v_mfma_f32_32x32x16_bf16 v[36:51], v[236:239], v[92:95], v[36:51]
    v_lshlrev_b32 v70, 16, v70
    v_mul_f32 v70, v12, v70
    v_lshlrev_b32 v71, 16, v71
    v_mul_f32 v71, v12, v71
    s_waitcnt lgkmcnt(3)
    v_mfma_f32_32x32x16_bf16 v[36:51], v[240:243], v[96:99], v[36:51]
    v_lshlrev_b32 v72, 16, v72
    v_mul_f32 v72, v12, v72
    v_lshlrev_b32 v73, 16, v73
    v_mul_f32 v73, v12, v73
    s_waitcnt lgkmcnt(2)
    v_mfma_f32_32x32x16_bf16 v[36:51], v[244:247], v[100:103], v[36:51]
    v_lshlrev_b32 v74, 16, v74
    v_mul_f32 v74, v12, v74
    v_lshlrev_b32 v75, 16, v75
    v_mul_f32 v75, v12, v75
    s_waitcnt lgkmcnt(1)
    v_mfma_f32_32x32x16_bf16 v[36:51], v[248:251], v[104:107], v[36:51]
    v_lshlrev_b32 v76, 16, v76
    v_mul_f32 v76, v12, v76
    v_lshlrev_b32 v77, 16, v77
    v_mul_f32 v77, v12, v77
    s_waitcnt lgkmcnt(0)
    v_mfma_f32_32x32x16_bf16 v[36:51], v[252:255], v[108:111], v[36:51]
    v_lshlrev_b32 v78, 16, v78
    v_mul_f32 v78, v12, v78
    v_lshlrev_b32 v79, 16, v79
    v_mul_f32 v79, v12, v79
    s_nop 7
    v_fma_f32 v64, v15, v36, v64
    v_fma_f32 v65, v15, v37, v65
    v_fma_f32 v66, v15, v38, v66
    v_fma_f32 v67, v15, v39, v67
    v_fma_f32 v68, v15, v40, v68
    v_fma_f32 v69, v15, v41, v69
    v_fma_f32 v70, v15, v42, v70
    v_fma_f32 v71, v15, v43, v71
    v_fma_f32 v72, v15, v44, v72
    v_fma_f32 v73, v15, v45, v73
    v_fma_f32 v74, v15, v46, v74
    v_fma_f32 v75, v15, v47, v75
    v_fma_f32 v76, v15, v48, v76
    v_fma_f32 v77, v15, v49, v77
    v_fma_f32 v78, v15, v50, v78
    v_fma_f32 v79, v15, v51, v79
    v_cvt_pk_bf16_f32 v16, v64, v65
    v_cvt_pk_bf16_f32 v17, v66, v67
    v_cvt_pk_bf16_f32 v18, v68, v69
    v_cvt_pk_bf16_f32 v19, v70, v71
    v_cvt_pk_bf16_f32 v20, v72, v73
    v_cvt_pk_bf16_f32 v21, v74, v75
    v_cvt_pk_bf16_f32 v22, v76, v77
    v_cvt_pk_bf16_f32 v23, v78, v79
    v_permlane32_swap_b32 v16, v18
    v_permlane32_swap_b32 v17, v19
    buffer_store_dwordx4 v[16:19], v13, s[20:23], s15 offen offset:0
    v_permlane32_swap_b32 v20, v22
    v_permlane32_swap_b32 v21, v23
    buffer_store_dwordx4 v[20:23], v13, s[20:23], s15 offen offset:32
    s_endpgm
K_EXIT:
    s_endpgm
.section .rodata,"a"
.p2align 6
.amdhsa_kernel gated_mix__linear_kernel_hedgehog__ssm_conv_s4__prompt_kernel
  .amdhsa_next_free_vgpr 256
  .amdhsa_next_free_sgpr 102
  .amdhsa_accum_offset 256
  .amdhsa_group_segment_fixed_size 0
  .amdhsa_kernarg_size 136
  .amdhsa_user_sgpr_count 2
  .amdhsa_user_sgpr_kernarg_segment_ptr 1
  .amdhsa_system_sgpr_workgroup_id_x 1
.end_amdhsa_kernel
```
